```python
import torch

def _softmax(x, axis=-1):
    return torch.softmax(x, dim=axis)
def _gelu(x):
    return torch.nn.functional.gelu(x, approximate="tanh")
def _silu(x):
    return torch.nn.functional.silu(x)
def _sigmoid(x):
    return torch.sigmoid(x)
def _layernorm(x, axis=-1, eps=1e-5):
    m = x.mean(dim=axis, keepdim=True)
    v = x.var(dim=axis, keepdim=True, unbiased=False)
    return (x - m) / torch.sqrt(v + eps)
def _scatter_add(tgt, idx, src, axis=0):
    return tgt.clone().index_add_(axis, idx, src)
def _segment_sum(src, seg, n):
    out = torch.zeros((n,) + src.shape[1:], dtype=src.dtype)
    return out.index_add_(0, seg, src)
def _pad(x, pw):
    flat = tuple(v for pair in reversed(pw) for v in pair)
    return torch.nn.functional.pad(x, flat)

kernel_name = 'recurrent_scan__ssm_conv_s5__geglu_ffn__prompt'

def setup_inputs():

    _w = (lambda a: (lambda t: t.to(torch.bfloat16) if t.is_floating_point() else t)(torch.as_tensor(a)))
    def _A_setup():
        B, S, D = 1, 2048, 1024
        P = D
        Lambda_re = -0.5 * (lambda _x: torch.exp(torch.as_tensor(_x)))((lambda *s: torch.randn(*s, dtype=torch.bfloat16) * 0.2)(P))
        Lambda_im = (lambda *s: torch.randn(*s, dtype=torch.bfloat16) * 0.4)(P) * 1.0
        B_re = (lambda *s: torch.randn(*s, dtype=torch.bfloat16) * 0.2)(P, D) * (D ** -0.5)
        B_im = (lambda *s: torch.randn(*s, dtype=torch.bfloat16) * 0.2)(P, D) * (D ** -0.5)
        C_re = (lambda *s: torch.randn(*s, dtype=torch.bfloat16) * 0.2)(D, P) * (P ** -0.5)
        C_im = (lambda *s: torch.randn(*s, dtype=torch.bfloat16) * 0.2)(D, P) * (P ** -0.5)
        log_dt = (lambda *s: torch.randn(*s, dtype=torch.bfloat16) * 0.2)(P) * 0.3 - 2.0
        Dskip = (lambda *s: torch.randn(*s, dtype=torch.bfloat16) * 0.05)(D)
        return {
            "x": _w((lambda *s: torch.randn(*s, dtype=torch.bfloat16) * 0.05)(B, S, D)),
            "Lambda_re": _w(Lambda_re),
            "Lambda_im": _w(Lambda_im),
            "B_re": _w(B_re),
            "B_im": _w(B_im),
            "C_re": _w(C_re),
            "C_im": _w(C_im),
            "log_dt": _w(log_dt),
            "Dskip": _w(Dskip),
        }
    _A_in = _A_setup()

    def _B_setup():
        B, S, D, F = 1, 2048, 1024, 3584
        return {
            "x": _w((lambda *s: torch.randn(*s, dtype=torch.bfloat16) * 0.05)(B, S, D)),
            "w_gate": _w((lambda *s: torch.randn(*s, dtype=torch.bfloat16) * 0.05)(D, F)),
            "w_up": _w((lambda *s: torch.randn(*s, dtype=torch.bfloat16) * 0.05)(D, F)),
            "w_down": _w((lambda *s: torch.randn(*s, dtype=torch.bfloat16) * 0.05)(F, D)),
        }
    _B_in = _B_setup()

    return {
        "A_x": _A_in["x"],
        "A_Lambda_re": _A_in["Lambda_re"],
        "A_Lambda_im": _A_in["Lambda_im"],
        "A_B_re": _A_in["B_re"],
        "A_B_im": _A_in["B_im"],
        "A_C_re": _A_in["C_re"],
        "A_C_im": _A_in["C_im"],
        "A_log_dt": _A_in["log_dt"],
        "A_Dskip": _A_in["Dskip"],
        "B_x": _B_in["x"],
        "B_w_gate": _B_in["w_gate"],
        "B_w_up": _B_in["w_up"],
        "B_w_down": _B_in["w_down"],
    }

def reference(A_x, A_Lambda_re, A_Lambda_im, A_B_re, A_B_im, A_C_re, A_C_im, A_log_dt, A_Dskip, B_x, B_w_gate, B_w_up, B_w_down):
    def _A_ref(x, Lambda_re, Lambda_im, B_re, B_im, C_re, C_im, log_dt, Dskip):
        Bsz, L, H = x.shape
        Lam = Lambda_re + 1j * Lambda_im
        Bmat = B_re + 1j * B_im
        Cmat = C_re + 1j * C_im
        dt = torch.exp(log_dt)
        Lam_bar = torch.exp(dt * Lam)
        B_bar = ((Lam_bar - 1.0) / Lam)[:, None] * Bmat
        Bu = torch.einsum("bld,pd->blp", x + 0j, B_bar)
        h = torch.zeros_like(Bu[:, 0, :])
        hs = []
        for t in range(L):
            h = Lam_bar[None, :] * h + Bu[:, t, :]
            hs.append(h)
        hseq = torch.stack(hs, 1)
        y = 2.0 * torch.einsum("blp,dp->bld", hseq, Cmat).real + x * Dskip[None, None, :]
        return y

    def _B_ref(x, w_gate, w_up, w_down):
        return (_gelu(x @ w_gate) * (x @ w_up)) @ w_down

    x = A_x
    xn = _layernorm(x, axis=-1)
    s = _A_ref(xn, A_Lambda_re, A_Lambda_im, A_B_re, A_B_im, A_C_re, A_C_im, A_log_dt, A_Dskip)
    g = _silu(_B_ref(xn, B_w_gate, B_w_up, B_w_down))
    return x + s * g
```

```asm
; @launch kernel=ln_kernel grid=(512,1,1) block=(256,1,1) lds=0
; @launch kernel=bu_kernel grid=(256,1,1) block=(256,1,1) lds=131072
; @launch kernel=scan_kernel grid=(128,1,1) block=(512,1,1) lds=8192
; @launch kernel=ffn1_kernel grid=(224,1,1) block=(512,1,1) lds=131072
; @launch kernel=fin_kernel grid=(256,1,1) block=(256,1,1) lds=98304
.amdgcn_target "amdgcn-amd-amdhsa--gfx950"
.text
.globl ln_kernel
.p2align 8
.type ln_kernel,@function
ln_kernel:

    s_cmp_ge_u32 s2, 512
    s_cbranch_scc1 L_ln_done
    s_load_dwordx2 s[4:5], s[0:1], 0
    s_load_dwordx2 s[6:7], s[0:1], 120
    s_waitcnt lgkmcnt(0)
    s_mov_b32 s8, s4
    s_mov_b32 s9, s5
    s_mov_b32 s10, 4194304
    s_mov_b32 s11, 0x00020000
    s_mov_b32 s12, s6
    s_mov_b32 s13, s7
    s_mov_b32 s14, 4194304
    s_mov_b32 s15, 0x00020000
    v_and_b32 v1, 63, v0
    v_lshrrev_b32 v2, 6, v0
    s_lshl_b32 s3, s2, 2
    v_add_u32 v2, s3, v2
    v_lshlrev_b32 v2, 11, v2
    v_lshl_add_u32 v2, v1, 5, v2
    buffer_load_dwordx4 v[4:7], v2, s[8:11], 0 offen
    buffer_load_dwordx4 v[8:11], v2, s[8:11], 0 offen offset:16
    s_waitcnt vmcnt(0)
    v_lshlrev_b32 v16, 16, v4
    v_and_b32 v17, 0xffff0000, v4
    v_lshlrev_b32 v18, 16, v5
    v_and_b32 v19, 0xffff0000, v5
    v_lshlrev_b32 v20, 16, v6
    v_and_b32 v21, 0xffff0000, v6
    v_lshlrev_b32 v22, 16, v7
    v_and_b32 v23, 0xffff0000, v7
    v_lshlrev_b32 v24, 16, v8
    v_and_b32 v25, 0xffff0000, v8
    v_lshlrev_b32 v26, 16, v9
    v_and_b32 v27, 0xffff0000, v9
    v_lshlrev_b32 v28, 16, v10
    v_and_b32 v29, 0xffff0000, v10
    v_lshlrev_b32 v30, 16, v11
    v_and_b32 v31, 0xffff0000, v11
    v_add_f32 v32, v16, v17
    v_add_f32 v32, v32, v18
    v_add_f32 v32, v32, v19
    v_add_f32 v32, v32, v20
    v_add_f32 v32, v32, v21
    v_add_f32 v32, v32, v22
    v_add_f32 v32, v32, v23
    v_add_f32 v32, v32, v24
    v_add_f32 v32, v32, v25
    v_add_f32 v32, v32, v26
    v_add_f32 v32, v32, v27
    v_add_f32 v32, v32, v28
    v_add_f32 v32, v32, v29
    v_add_f32 v32, v32, v30
    v_add_f32 v32, v32, v31
    ds_swizzle_b32 v33, v32 offset:0x041F
    s_waitcnt lgkmcnt(0)
    v_add_f32 v32, v32, v33
    ds_swizzle_b32 v33, v32 offset:0x081F
    s_waitcnt lgkmcnt(0)
    v_add_f32 v32, v32, v33
    ds_swizzle_b32 v33, v32 offset:0x101F
    s_waitcnt lgkmcnt(0)
    v_add_f32 v32, v32, v33
    ds_swizzle_b32 v33, v32 offset:0x201F
    s_waitcnt lgkmcnt(0)
    v_add_f32 v32, v32, v33
    ds_swizzle_b32 v33, v32 offset:0x401F
    s_waitcnt lgkmcnt(0)
    v_add_f32 v32, v32, v33
    s_nop 0
    v_readlane_b32 s20, v32, 0
    v_readlane_b32 s21, v32, 32
    s_nop 1
    v_mov_b32 v32, s20
    v_add_f32 v32, s21, v32
    v_mul_f32 v32, 0x3a800000, v32
    v_sub_f32 v34, v16, v32
    v_mul_f32 v35, v34, v34
    v_sub_f32 v34, v17, v32
    v_fmac_f32 v35, v34, v34
    v_sub_f32 v34, v18, v32
    v_fmac_f32 v35, v34, v34
    v_sub_f32 v34, v19, v32
    v_fmac_f32 v35, v34, v34
    v_sub_f32 v34, v20, v32
    v_fmac_f32 v35, v34, v34
    v_sub_f32 v34, v21, v32
    v_fmac_f32 v35, v34, v34
    v_sub_f32 v34, v22, v32
    v_fmac_f32 v35, v34, v34
    v_sub_f32 v34, v23, v32
    v_fmac_f32 v35, v34, v34
    v_sub_f32 v34, v24, v32
    v_fmac_f32 v35, v34, v34
    v_sub_f32 v34, v25, v32
    v_fmac_f32 v35, v34, v34
    v_sub_f32 v34, v26, v32
    v_fmac_f32 v35, v34, v34
    v_sub_f32 v34, v27, v32
    v_fmac_f32 v35, v34, v34
    v_sub_f32 v34, v28, v32
    v_fmac_f32 v35, v34, v34
    v_sub_f32 v34, v29, v32
    v_fmac_f32 v35, v34, v34
    v_sub_f32 v34, v30, v32
    v_fmac_f32 v35, v34, v34
    v_sub_f32 v34, v31, v32
    v_fmac_f32 v35, v34, v34
    ds_swizzle_b32 v33, v35 offset:0x041F
    s_waitcnt lgkmcnt(0)
    v_add_f32 v35, v35, v33
    ds_swizzle_b32 v33, v35 offset:0x081F
    s_waitcnt lgkmcnt(0)
    v_add_f32 v35, v35, v33
    ds_swizzle_b32 v33, v35 offset:0x101F
    s_waitcnt lgkmcnt(0)
    v_add_f32 v35, v35, v33
    ds_swizzle_b32 v33, v35 offset:0x201F
    s_waitcnt lgkmcnt(0)
    v_add_f32 v35, v35, v33
    ds_swizzle_b32 v33, v35 offset:0x401F
    s_waitcnt lgkmcnt(0)
    v_add_f32 v35, v35, v33
    s_nop 0
    v_readlane_b32 s20, v35, 0
    v_readlane_b32 s21, v35, 32
    s_nop 1
    v_mov_b32 v35, s20
    v_add_f32 v35, s21, v35
    v_mul_f32 v35, 0x3a800000, v35
    v_cvt_pk_bf16_f32 v36, v32, v35
    v_lshlrev_b32 v32, 16, v36
    v_and_b32 v35, 0xffff0000, v36
    v_add_f32 v35, 0x3727c5ac, v35
    v_cvt_pk_bf16_f32 v36, v35, v35
    v_lshlrev_b32 v35, 16, v36
    v_sqrt_f32 v35, v35
    s_nop 0
    v_cvt_pk_bf16_f32 v36, v35, v35
    v_lshlrev_b32 v35, 16, v36
    v_rcp_f32 v37, v35
    s_nop 0
    v_sub_f32 v16, v16, v32
    v_cvt_pk_bf16_f32 v16, v16, v16
    v_lshlrev_b32 v16, 16, v16
    v_mul_f32 v38, v16, v37
    v_fma_f32 v39, -v38, v35, v16
    v_fma_f32 v16, v39, v37, v38
    v_sub_f32 v17, v17, v32
    v_cvt_pk_bf16_f32 v17, v17, v17
    v_lshlrev_b32 v17, 16, v17
    v_mul_f32 v38, v17, v37
    v_fma_f32 v39, -v38, v35, v17
    v_fma_f32 v17, v39, v37, v38
    v_sub_f32 v18, v18, v32
    v_cvt_pk_bf16_f32 v18, v18, v18
    v_lshlrev_b32 v18, 16, v18
    v_mul_f32 v38, v18, v37
    v_fma_f32 v39, -v38, v35, v18
    v_fma_f32 v18, v39, v37, v38
    v_sub_f32 v19, v19, v32
    v_cvt_pk_bf16_f32 v19, v19, v19
    v_lshlrev_b32 v19, 16, v19
    v_mul_f32 v38, v19, v37
    v_fma_f32 v39, -v38, v35, v19
    v_fma_f32 v19, v39, v37, v38
    v_sub_f32 v20, v20, v32
    v_cvt_pk_bf16_f32 v20, v20, v20
    v_lshlrev_b32 v20, 16, v20
    v_mul_f32 v38, v20, v37
    v_fma_f32 v39, -v38, v35, v20
    v_fma_f32 v20, v39, v37, v38
    v_sub_f32 v21, v21, v32
    v_cvt_pk_bf16_f32 v21, v21, v21
    v_lshlrev_b32 v21, 16, v21
    v_mul_f32 v38, v21, v37
    v_fma_f32 v39, -v38, v35, v21
    v_fma_f32 v21, v39, v37, v38
    v_sub_f32 v22, v22, v32
    v_cvt_pk_bf16_f32 v22, v22, v22
    v_lshlrev_b32 v22, 16, v22
    v_mul_f32 v38, v22, v37
    v_fma_f32 v39, -v38, v35, v22
    v_fma_f32 v22, v39, v37, v38
    v_sub_f32 v23, v23, v32
    v_cvt_pk_bf16_f32 v23, v23, v23
    v_lshlrev_b32 v23, 16, v23
    v_mul_f32 v38, v23, v37
    v_fma_f32 v39, -v38, v35, v23
    v_fma_f32 v23, v39, v37, v38
    v_sub_f32 v24, v24, v32
    v_cvt_pk_bf16_f32 v24, v24, v24
    v_lshlrev_b32 v24, 16, v24
    v_mul_f32 v38, v24, v37
    v_fma_f32 v39, -v38, v35, v24
    v_fma_f32 v24, v39, v37, v38
    v_sub_f32 v25, v25, v32
    v_cvt_pk_bf16_f32 v25, v25, v25
    v_lshlrev_b32 v25, 16, v25
    v_mul_f32 v38, v25, v37
    v_fma_f32 v39, -v38, v35, v25
    v_fma_f32 v25, v39, v37, v38
    v_sub_f32 v26, v26, v32
    v_cvt_pk_bf16_f32 v26, v26, v26
    v_lshlrev_b32 v26, 16, v26
    v_mul_f32 v38, v26, v37
    v_fma_f32 v39, -v38, v35, v26
    v_fma_f32 v26, v39, v37, v38
    v_sub_f32 v27, v27, v32
    v_cvt_pk_bf16_f32 v27, v27, v27
    v_lshlrev_b32 v27, 16, v27
    v_mul_f32 v38, v27, v37
    v_fma_f32 v39, -v38, v35, v27
    v_fma_f32 v27, v39, v37, v38
    v_sub_f32 v28, v28, v32
    v_cvt_pk_bf16_f32 v28, v28, v28
    v_lshlrev_b32 v28, 16, v28
    v_mul_f32 v38, v28, v37
    v_fma_f32 v39, -v38, v35, v28
    v_fma_f32 v28, v39, v37, v38
    v_sub_f32 v29, v29, v32
    v_cvt_pk_bf16_f32 v29, v29, v29
    v_lshlrev_b32 v29, 16, v29
    v_mul_f32 v38, v29, v37
    v_fma_f32 v39, -v38, v35, v29
    v_fma_f32 v29, v39, v37, v38
    v_sub_f32 v30, v30, v32
    v_cvt_pk_bf16_f32 v30, v30, v30
    v_lshlrev_b32 v30, 16, v30
    v_mul_f32 v38, v30, v37
    v_fma_f32 v39, -v38, v35, v30
    v_fma_f32 v30, v39, v37, v38
    v_sub_f32 v31, v31, v32
    v_cvt_pk_bf16_f32 v31, v31, v31
    v_lshlrev_b32 v31, 16, v31
    v_mul_f32 v38, v31, v37
    v_fma_f32 v39, -v38, v35, v31
    v_fma_f32 v31, v39, v37, v38
    v_cvt_pk_bf16_f32 v4, v16, v17
    v_cvt_pk_bf16_f32 v5, v18, v19
    v_cvt_pk_bf16_f32 v6, v20, v21
    v_cvt_pk_bf16_f32 v7, v22, v23
    v_cvt_pk_bf16_f32 v8, v24, v25
    v_cvt_pk_bf16_f32 v9, v26, v27
    v_cvt_pk_bf16_f32 v10, v28, v29
    v_cvt_pk_bf16_f32 v11, v30, v31
    buffer_store_dwordx4 v[4:7], v2, s[12:15], 0 offen
    buffer_store_dwordx4 v[8:11], v2, s[12:15], 0 offen offset:16
    s_cmp_ge_u32 s2, 4
    s_cbranch_scc1 L_ln_end
    s_load_dwordx2 s[16:17], s[0:1], 8
    s_load_dwordx2 s[18:19], s[0:1], 16
    s_load_dwordx2 s[20:21], s[0:1], 56
    s_waitcnt lgkmcnt(0)
    s_mov_b32 s24, s16
    s_mov_b32 s25, s17
    s_mov_b32 s26, 2048
    s_mov_b32 s27, 0x00020000
    s_mov_b32 s28, s18
    s_mov_b32 s29, s19
    s_mov_b32 s30, 2048
    s_mov_b32 s31, 0x00020000
    s_mov_b32 s32, s20
    s_mov_b32 s33, s21
    s_mov_b32 s34, 2048
    s_mov_b32 s35, 0x00020000
    s_lshl_b32 s3, s2, 8
    v_add_u32 v1, s3, v0
    v_lshlrev_b32 v2, 1, v1
    buffer_load_ushort v4, v2, s[24:27], 0 offen
    buffer_load_ushort v5, v2, s[28:31], 0 offen
    buffer_load_ushort v6, v2, s[32:35], 0 offen
    s_waitcnt vmcnt(0)
    v_lshlrev_b32 v4, 16, v4
    v_lshlrev_b32 v5, 16, v5
    v_lshlrev_b32 v6, 16, v6
    v_mul_f32 v6, 0x3fb8aa3b, v6
    v_exp_f32 v6, v6
    s_nop 0
    v_cvt_pk_bf16_f32 v6, v6, v6
    v_lshlrev_b32 v6, 16, v6
    v_mul_f32 v7, v6, v4
    v_mul_f32 v8, v6, v5
    v_mul_f32 v9, 0x3fb8aa3b, v7
    v_exp_f32 v9, v9
    v_mul_f32 v10, 0x3e22f983, v8
    v_cos_f32 v11, v10
    v_sin_f32 v12, v10
    s_nop 0
    v_mul_f32 v16, v9, v11
    v_mul_f32 v17, v9, v12
    v_add_f32 v13, -1.0, v16
    v_mul_f32 v14, v4, v4
    v_fmac_f32 v14, v5, v5
    v_rcp_f32 v14, v14
    v_mul_f32 v18, v13, v4
    v_fmac_f32 v18, v17, v5
    v_mul_f32 v19, v17, v4
    v_fma_f32 v19, -v13, v5, v19
    v_mul_f32 v18, v18, v14
    v_mul_f32 v19, v19, v14
    s_add_u32 s6, s6, 4194304
    s_addc_u32 s7, s7, 0
    s_mov_b32 s12, s6
    s_mov_b32 s13, s7
    s_mov_b32 s14, 16384
    s_mov_b32 s15, 0x00020000
    v_lshlrev_b32 v2, 4, v1
    buffer_store_dwordx4 v[16:19], v2, s[12:15], 0 offen
L_ln_end:
    s_waitcnt vmcnt(0)
L_ln_done:
    s_endpgm
.globl bu_kernel
.p2align 8
.type bu_kernel,@function
bu_kernel:

    s_cmp_ge_u32 s2, 256
    s_cbranch_scc1 L_bu_done
    s_load_dwordx2 s[4:5], s[0:1], 24
    s_load_dwordx2 s[6:7], s[0:1], 32
    s_load_dwordx2 s[28:29], s[0:1], 120
    s_waitcnt lgkmcnt(0)
    s_mov_b32 s8, s28
    s_mov_b32 s9, s29
    s_mov_b32 s10, 4194304
    s_mov_b32 s11, 0x00020000
    s_mov_b32 s12, s4
    s_mov_b32 s13, s5
    s_mov_b32 s14, 2097152
    s_mov_b32 s15, 0x00020000
    s_mov_b32 s16, s6
    s_mov_b32 s17, s7
    s_mov_b32 s18, 2097152
    s_mov_b32 s19, 0x00020000
    s_add_u32 s36, s28, 4194304
    s_addc_u32 s37, s29, 0
    s_mov_b32 s40, s36
    s_mov_b32 s41, s37
    s_mov_b32 s42, 16384
    s_mov_b32 s43, 0x00020000
    s_add_u32 s28, s28, 8388608
    s_addc_u32 s29, s29, 0
    s_mov_b32 s20, s28
    s_mov_b32 s21, s29
    s_mov_b32 s22, 16777216
    s_mov_b32 s23, 0x00020000
    v_lshrrev_b32 v1, 6, v0
    s_nop 0
    v_readfirstlane_b32 s3, v1
    v_and_b32 v1, 63, v0
    s_lshl_b32 s4, s3, 10
    s_and_b32 s30, s2, 15
    s_lshr_b32 s31, s2, 4
    s_mul_i32 s24, s30, 128*2048
    s_mul_i32 s25, s31, 64*2048
    s_mov_b32 s26, s25
    s_and_b32 s32, s3, 1
    s_lshl_b32 s32, s32, 6
    s_lshr_b32 s33, s3, 1
    s_lshl_b32 s33, s33, 5
    v_lshrrev_b32 v2, 3, v1
    v_and_b32 v3, 7, v1
    v_lshrrev_b32 v4, 1, v2
    s_and_b32 s90, s3, 1
    s_lshl_b32 s90, s90, 2
    v_add_u32 v4, s90, v4
    v_xor_b32 v3, v3, v4
    v_lshlrev_b32 v3, 4, v3
    s_lshl_b32 s90, s3, 3
    v_add_u32 v2, s90, v2
    s_mov_b32 s90, 2048
    v_mul_lo_u32 v2, v2, s90
    v_add_u32 v8, v2, v3
    v_lshrrev_b32 v2, 3, v1
    v_and_b32 v3, 7, v1
    v_lshrrev_b32 v4, 1, v2
    s_and_b32 s90, s3, 1
    s_lshl_b32 s90, s90, 2
    v_add_u32 v4, s90, v4
    v_xor_b32 v3, v3, v4
    v_lshlrev_b32 v3, 4, v3
    s_lshl_b32 s90, s3, 3
    v_add_u32 v2, s90, v2
    s_mov_b32 s90, 2048
    v_mul_lo_u32 v2, v2, s90
    v_add_u32 v9, v2, v3
    v_lshrrev_b32 v2, 3, v1
    v_and_b32 v3, 7, v1
    v_lshrrev_b32 v4, 1, v2
    s_and_b32 s90, s3, 1
    s_lshl_b32 s90, s90, 2
    v_add_u32 v4, s90, v4
    v_xor_b32 v3, v3, v4
    v_lshlrev_b32 v3, 4, v3
    s_lshl_b32 s90, s3, 3
    v_add_u32 v2, s90, v2
    s_mov_b32 s90, 2048
    v_mul_lo_u32 v2, v2, s90
    v_add_u32 v10, v2, v3
    v_and_b32 v2, 31, v1
    v_lshrrev_b32 v3, 5, v1
    v_lshrrev_b32 v4, 1, v2
    v_and_b32 v4, 7, v4
    v_add_u32 v2, s32, v2
    v_lshlrev_b32 v2, 7, v2
    v_add_u32 v11, 0, v3
    v_xor_b32 v11, v11, v4
    v_lshlrev_b32 v11, 4, v11
    v_add_u32 v11, v11, v2
    v_add_u32 v12, 2, v3
    v_xor_b32 v12, v12, v4
    v_lshlrev_b32 v12, 4, v12
    v_add_u32 v12, v12, v2
    v_add_u32 v13, 4, v3
    v_xor_b32 v13, v13, v4
    v_lshlrev_b32 v13, 4, v13
    v_add_u32 v13, v13, v2
    v_add_u32 v14, 6, v3
    v_xor_b32 v14, v14, v4
    v_lshlrev_b32 v14, 4, v14
    v_add_u32 v14, v14, v2
    v_and_b32 v2, 31, v1
    v_lshrrev_b32 v3, 5, v1
    v_lshrrev_b32 v4, 1, v2
    v_and_b32 v4, 7, v4
    v_add_u32 v2, s33, v2
    v_lshlrev_b32 v2, 7, v2
    v_add_u32 v15, 0, v3
    v_xor_b32 v15, v15, v4
    v_lshlrev_b32 v15, 4, v15
    v_add_u32 v15, v15, v2
    v_add_u32 v15, 16384, v15
    v_add_u32 v16, 2, v3
    v_xor_b32 v16, v16, v4
    v_lshlrev_b32 v16, 4, v16
    v_add_u32 v16, v16, v2
    v_add_u32 v16, 16384, v16
    v_add_u32 v17, 4, v3
    v_xor_b32 v17, v17, v4
    v_lshlrev_b32 v17, 4, v17
    v_add_u32 v17, v17, v2
    v_add_u32 v17, 16384, v17
    v_add_u32 v18, 6, v3
    v_xor_b32 v18, v18, v4
    v_lshlrev_b32 v18, 4, v18
    v_add_u32 v18, v18, v2
    v_add_u32 v18, 16384, v18
    v_and_b32 v2, 31, v1
    v_lshrrev_b32 v3, 5, v1
    v_lshrrev_b32 v4, 1, v2
    v_and_b32 v4, 7, v4
    v_add_u32 v2, s33, v2
    v_lshlrev_b32 v2, 7, v2
    v_add_u32 v19, 0, v3
    v_xor_b32 v19, v19, v4
    v_lshlrev_b32 v19, 4, v19
    v_add_u32 v19, v19, v2
    v_add_u32 v19, 24576, v19
    v_add_u32 v20, 2, v3
    v_xor_b32 v20, v20, v4
    v_lshlrev_b32 v20, 4, v20
    v_add_u32 v20, v20, v2
    v_add_u32 v20, 24576, v20
    v_add_u32 v21, 4, v3
    v_xor_b32 v21, v21, v4
    v_lshlrev_b32 v21, 4, v21
    v_add_u32 v21, v21, v2
    v_add_u32 v21, 24576, v21
    v_add_u32 v22, 6, v3
    v_xor_b32 v22, v22, v4
    v_lshlrev_b32 v22, 4, v22
    v_add_u32 v22, v22, v2
    v_add_u32 v22, 24576, v22
    v_mov_b32 v24, 0
    v_mov_b32 v25, 0
    v_mov_b32 v26, 0
    v_mov_b32 v27, 0
    v_mov_b32 v28, 0
    v_mov_b32 v29, 0
    v_mov_b32 v30, 0
    v_mov_b32 v31, 0
    v_mov_b32 v32, 0
    v_mov_b32 v33, 0
    v_mov_b32 v34, 0
    v_mov_b32 v35, 0
    v_mov_b32 v36, 0
    v_mov_b32 v37, 0
    v_mov_b32 v38, 0
    v_mov_b32 v39, 0
    v_mov_b32 v40, 0
    v_mov_b32 v41, 0
    v_mov_b32 v42, 0
    v_mov_b32 v43, 0
    v_mov_b32 v44, 0
    v_mov_b32 v45, 0
    v_mov_b32 v46, 0
    v_mov_b32 v47, 0
    v_mov_b32 v48, 0
    v_mov_b32 v49, 0
    v_mov_b32 v50, 0
    v_mov_b32 v51, 0
    v_mov_b32 v52, 0
    v_mov_b32 v53, 0
    v_mov_b32 v54, 0
    v_mov_b32 v55, 0
    v_mov_b32 v56, 0
    v_mov_b32 v57, 0
    v_mov_b32 v58, 0
    v_mov_b32 v59, 0
    v_mov_b32 v60, 0
    v_mov_b32 v61, 0
    v_mov_b32 v62, 0
    v_mov_b32 v63, 0
    v_mov_b32 v64, 0
    v_mov_b32 v65, 0
    v_mov_b32 v66, 0
    v_mov_b32 v67, 0
    v_mov_b32 v68, 0
    v_mov_b32 v69, 0
    v_mov_b32 v70, 0
    v_mov_b32 v71, 0
    v_mov_b32 v72, 0
    v_mov_b32 v73, 0
    v_mov_b32 v74, 0
    v_mov_b32 v75, 0
    v_mov_b32 v76, 0
    v_mov_b32 v77, 0
    v_mov_b32 v78, 0
    v_mov_b32 v79, 0
    v_mov_b32 v80, 0
    v_mov_b32 v81, 0
    v_mov_b32 v82, 0
    v_mov_b32 v83, 0
    v_mov_b32 v84, 0
    v_mov_b32 v85, 0
    v_mov_b32 v86, 0
    v_mov_b32 v87, 0
    s_add_u32 m0, s4, 0
    s_nop 0
    buffer_load_dwordx4 v8, s[8:11], s24 offen lds
    s_add_u32 m0, s4, 4096
    s_add_u32 s91, s24, 65536
    buffer_load_dwordx4 v8, s[8:11], s91 offen lds
    s_add_u32 m0, s4, 8192
    s_add_u32 s91, s24, 131072
    buffer_load_dwordx4 v8, s[8:11], s91 offen lds
    s_add_u32 m0, s4, 12288
    s_add_u32 s91, s24, 196608
    buffer_load_dwordx4 v8, s[8:11], s91 offen lds
    s_add_u32 m0, s4, 16384
    s_nop 0
    buffer_load_dwordx4 v9, s[12:15], s25 offen lds
    s_add_u32 m0, s4, 20480
    s_add_u32 s91, s25, 65536
    buffer_load_dwordx4 v9, s[12:15], s91 offen lds
    s_add_u32 m0, s4, 24576
    s_nop 0
    buffer_load_dwordx4 v10, s[16:19], s26 offen lds
    s_add_u32 m0, s4, 28672
    s_add_u32 s91, s26, 65536
    buffer_load_dwordx4 v10, s[16:19], s91 offen lds
    s_add_u32 s24, s24, 128
    s_add_u32 s25, s25, 128
    s_add_u32 s26, s26, 128
    s_add_u32 m0, s4, 32768
    s_nop 0
    buffer_load_dwordx4 v8, s[8:11], s24 offen lds
    s_add_u32 m0, s4, 36864
    s_add_u32 s91, s24, 65536
    buffer_load_dwordx4 v8, s[8:11], s91 offen lds
    s_add_u32 m0, s4, 40960
    s_add_u32 s91, s24, 131072
    buffer_load_dwordx4 v8, s[8:11], s91 offen lds
    s_add_u32 m0, s4, 45056
    s_add_u32 s91, s24, 196608
    buffer_load_dwordx4 v8, s[8:11], s91 offen lds
    s_add_u32 m0, s4, 49152
    s_nop 0
    buffer_load_dwordx4 v9, s[12:15], s25 offen lds
    s_add_u32 m0, s4, 53248
    s_add_u32 s91, s25, 65536
    buffer_load_dwordx4 v9, s[12:15], s91 offen lds
    s_add_u32 m0, s4, 57344
    s_nop 0
    buffer_load_dwordx4 v10, s[16:19], s26 offen lds
    s_add_u32 m0, s4, 61440
    s_add_u32 s91, s26, 65536
    buffer_load_dwordx4 v10, s[16:19], s91 offen lds
    s_add_u32 s24, s24, 128
    s_add_u32 s25, s25, 128
    s_add_u32 s26, s26, 128
    s_add_u32 m0, s4, 65536
    s_nop 0
    buffer_load_dwordx4 v8, s[8:11], s24 offen lds
    s_add_u32 m0, s4, 69632
    s_add_u32 s91, s24, 65536
    buffer_load_dwordx4 v8, s[8:11], s91 offen lds
    s_add_u32 m0, s4, 73728
    s_add_u32 s91, s24, 131072
    buffer_load_dwordx4 v8, s[8:11], s91 offen lds
    s_add_u32 m0, s4, 77824
    s_add_u32 s91, s24, 196608
    buffer_load_dwordx4 v8, s[8:11], s91 offen lds
    s_add_u32 m0, s4, 81920
    s_nop 0
    buffer_load_dwordx4 v9, s[12:15], s25 offen lds
    s_add_u32 m0, s4, 86016
    s_add_u32 s91, s25, 65536
    buffer_load_dwordx4 v9, s[12:15], s91 offen lds
    s_add_u32 m0, s4, 90112
    s_nop 0
    buffer_load_dwordx4 v10, s[16:19], s26 offen lds
    s_add_u32 m0, s4, 94208
    s_add_u32 s91, s26, 65536
    buffer_load_dwordx4 v10, s[16:19], s91 offen lds
    s_add_u32 s24, s24, 128
    s_add_u32 s25, s25, 128
    s_add_u32 s26, s26, 128
    s_mov_b32 s92, 3
L_k_1:
    s_waitcnt vmcnt(16)
    s_barrier
    ds_read_b128 v[88:91], v11 offset:0
    ds_read_b128 v[92:95], v11 offset:4096
    ds_read_b128 v[96:99], v15 offset:0
    ds_read_b128 v[100:103], v19 offset:0
    s_add_u32 m0, s4, 98304
    s_nop 0
    buffer_load_dwordx4 v8, s[8:11], s24 offen lds
    s_add_u32 m0, s4, 102400
    s_add_u32 s91, s24, 65536
    buffer_load_dwordx4 v8, s[8:11], s91 offen lds
    s_add_u32 m0, s4, 106496
    s_add_u32 s91, s24, 131072
    buffer_load_dwordx4 v8, s[8:11], s91 offen lds
    s_add_u32 m0, s4, 110592
    s_add_u32 s91, s24, 196608
    buffer_load_dwordx4 v8, s[8:11], s91 offen lds
    s_add_u32 m0, s4, 114688
    s_nop 0
    buffer_load_dwordx4 v9, s[12:15], s25 offen lds
    s_add_u32 m0, s4, 118784
    s_add_u32 s91, s25, 65536
    buffer_load_dwordx4 v9, s[12:15], s91 offen lds
    s_add_u32 m0, s4, 122880
    s_nop 0
    buffer_load_dwordx4 v10, s[16:19], s26 offen lds
    s_add_u32 m0, s4, 126976
    s_add_u32 s91, s26, 65536
    buffer_load_dwordx4 v10, s[16:19], s91 offen lds
    s_add_u32 s24, s24, 128
    s_add_u32 s25, s25, 128
    s_add_u32 s26, s26, 128
    ds_read_b128 v[104:107], v12 offset:0
    ds_read_b128 v[108:111], v12 offset:4096
    ds_read_b128 v[112:115], v16 offset:0
    ds_read_b128 v[116:119], v20 offset:0
    s_waitcnt lgkmcnt(4)
    v_mfma_f32_32x32x16_bf16 v[24:39], v[88:91], v[96:99], v[24:39]
    v_mfma_f32_32x32x16_bf16 v[40:55], v[92:95], v[96:99], v[40:55]
    v_mfma_f32_32x32x16_bf16 v[56:71], v[88:91], v[100:103], v[56:71]
    v_mfma_f32_32x32x16_bf16 v[72:87], v[92:95], v[100:103], v[72:87]
    ds_read_b128 v[88:91], v13 offset:0
    ds_read_b128 v[92:95], v13 offset:4096
    ds_read_b128 v[96:99], v17 offset:0
    ds_read_b128 v[100:103], v21 offset:0
    s_waitcnt lgkmcnt(4)
    v_mfma_f32_32x32x16_bf16 v[24:39], v[104:107], v[112:115], v[24:39]
    v_mfma_f32_32x32x16_bf16 v[40:55], v[108:111], v[112:115], v[40:55]
    v_mfma_f32_32x32x16_bf16 v[56:71], v[104:107], v[116:119], v[56:71]
    v_mfma_f32_32x32x16_bf16 v[72:87], v[108:111], v[116:119], v[72:87]
    ds_read_b128 v[104:107], v14 offset:0
    ds_read_b128 v[108:111], v14 offset:4096
    ds_read_b128 v[112:115], v18 offset:0
    ds_read_b128 v[116:119], v22 offset:0
    s_waitcnt lgkmcnt(4)
    v_mfma_f32_32x32x16_bf16 v[24:39], v[88:91], v[96:99], v[24:39]
    v_mfma_f32_32x32x16_bf16 v[40:55], v[92:95], v[96:99], v[40:55]
    v_mfma_f32_32x32x16_bf16 v[56:71], v[88:91], v[100:103], v[56:71]
    v_mfma_f32_32x32x16_bf16 v[72:87], v[92:95], v[100:103], v[72:87]
    s_waitcnt lgkmcnt(0)
    v_mfma_f32_32x32x16_bf16 v[24:39], v[104:107], v[112:115], v[24:39]
    v_mfma_f32_32x32x16_bf16 v[40:55], v[108:111], v[112:115], v[40:55]
    v_mfma_f32_32x32x16_bf16 v[56:71], v[104:107], v[116:119], v[56:71]
    v_mfma_f32_32x32x16_bf16 v[72:87], v[108:111], v[116:119], v[72:87]
    s_waitcnt vmcnt(16)
    s_barrier
    v_add_u32 v11, 32768, v11
    v_add_u32 v12, 32768, v12
    v_add_u32 v13, 32768, v13
    v_add_u32 v14, 32768, v14
    v_add_u32 v15, 32768, v15
    v_add_u32 v16, 32768, v16
    v_add_u32 v17, 32768, v17
    v_add_u32 v18, 32768, v18
    v_add_u32 v19, 32768, v19
    v_add_u32 v20, 32768, v20
    v_add_u32 v21, 32768, v21
    v_add_u32 v22, 32768, v22
    ds_read_b128 v[88:91], v11 offset:0
    ds_read_b128 v[92:95], v11 offset:4096
    ds_read_b128 v[96:99], v15 offset:0
    ds_read_b128 v[100:103], v19 offset:0
    s_add_u32 m0, s4, 0
    s_nop 0
    buffer_load_dwordx4 v8, s[8:11], s24 offen lds
    s_add_u32 m0, s4, 4096
    s_add_u32 s91, s24, 65536
    buffer_load_dwordx4 v8, s[8:11], s91 offen lds
    s_add_u32 m0, s4, 8192
    s_add_u32 s91, s24, 131072
    buffer_load_dwordx4 v8, s[8:11], s91 offen lds
    s_add_u32 m0, s4, 12288
    s_add_u32 s91, s24, 196608
    buffer_load_dwordx4 v8, s[8:11], s91 offen lds
    s_add_u32 m0, s4, 16384
    s_nop 0
    buffer_load_dwordx4 v9, s[12:15], s25 offen lds
    s_add_u32 m0, s4, 20480
    s_add_u32 s91, s25, 65536
    buffer_load_dwordx4 v9, s[12:15], s91 offen lds
    s_add_u32 m0, s4, 24576
    s_nop 0
    buffer_load_dwordx4 v10, s[16:19], s26 offen lds
    s_add_u32 m0, s4, 28672
    s_add_u32 s91, s26, 65536
    buffer_load_dwordx4 v10, s[16:19], s91 offen lds
    s_add_u32 s24, s24, 128
    s_add_u32 s25, s25, 128
    s_add_u32 s26, s26, 128
    ds_read_b128 v[104:107], v12 offset:0
    ds_read_b128 v[108:111], v12 offset:4096
    ds_read_b128 v[112:115], v16 offset:0
    ds_read_b128 v[116:119], v20 offset:0
    s_waitcnt lgkmcnt(4)
    v_mfma_f32_32x32x16_bf16 v[24:39], v[88:91], v[96:99], v[24:39]
    v_mfma_f32_32x32x16_bf16 v[40:55], v[92:95], v[96:99], v[40:55]
    v_mfma_f32_32x32x16_bf16 v[56:71], v[88:91], v[100:103], v[56:71]
    v_mfma_f32_32x32x16_bf16 v[72:87], v[92:95], v[100:103], v[72:87]
    ds_read_b128 v[88:91], v13 offset:0
    ds_read_b128 v[92:95], v13 offset:4096
    ds_read_b128 v[96:99], v17 offset:0
    ds_read_b128 v[100:103], v21 offset:0
    s_waitcnt lgkmcnt(4)
    v_mfma_f32_32x32x16_bf16 v[24:39], v[104:107], v[112:115], v[24:39]
    v_mfma_f32_32x32x16_bf16 v[40:55], v[108:111], v[112:115], v[40:55]
    v_mfma_f32_32x32x16_bf16 v[56:71], v[104:107], v[116:119], v[56:71]
    v_mfma_f32_32x32x16_bf16 v[72:87], v[108:111], v[116:119], v[72:87]
    ds_read_b128 v[104:107], v14 offset:0
    ds_read_b128 v[108:111], v14 offset:4096
    ds_read_b128 v[112:115], v18 offset:0
    ds_read_b128 v[116:119], v22 offset:0
    s_waitcnt lgkmcnt(4)
    v_mfma_f32_32x32x16_bf16 v[24:39], v[88:91], v[96:99], v[24:39]
    v_mfma_f32_32x32x16_bf16 v[40:55], v[92:95], v[96:99], v[40:55]
    v_mfma_f32_32x32x16_bf16 v[56:71], v[88:91], v[100:103], v[56:71]
    v_mfma_f32_32x32x16_bf16 v[72:87], v[92:95], v[100:103], v[72:87]
    s_waitcnt lgkmcnt(0)
    v_mfma_f32_32x32x16_bf16 v[24:39], v[104:107], v[112:115], v[24:39]
    v_mfma_f32_32x32x16_bf16 v[40:55], v[108:111], v[112:115], v[40:55]
    v_mfma_f32_32x32x16_bf16 v[56:71], v[104:107], v[116:119], v[56:71]
    v_mfma_f32_32x32x16_bf16 v[72:87], v[108:111], v[116:119], v[72:87]
    s_waitcnt vmcnt(16)
    s_barrier
    v_add_u32 v11, 32768, v11
    v_add_u32 v12, 32768, v12
    v_add_u32 v13, 32768, v13
    v_add_u32 v14, 32768, v14
    v_add_u32 v15, 32768, v15
    v_add_u32 v16, 32768, v16
    v_add_u32 v17, 32768, v17
    v_add_u32 v18, 32768, v18
    v_add_u32 v19, 32768, v19
    v_add_u32 v20, 32768, v20
    v_add_u32 v21, 32768, v21
    v_add_u32 v22, 32768, v22
    ds_read_b128 v[88:91], v11 offset:0
    ds_read_b128 v[92:95], v11 offset:4096
    ds_read_b128 v[96:99], v15 offset:0
    ds_read_b128 v[100:103], v19 offset:0
    s_add_u32 m0, s4, 32768
    s_nop 0
    buffer_load_dwordx4 v8, s[8:11], s24 offen lds
    s_add_u32 m0, s4, 36864
    s_add_u32 s91, s24, 65536
    buffer_load_dwordx4 v8, s[8:11], s91 offen lds
    s_add_u32 m0, s4, 40960
    s_add_u32 s91, s24, 131072
    buffer_load_dwordx4 v8, s[8:11], s91 offen lds
    s_add_u32 m0, s4, 45056
    s_add_u32 s91, s24, 196608
    buffer_load_dwordx4 v8, s[8:11], s91 offen lds
    s_add_u32 m0, s4, 49152
    s_nop 0
    buffer_load_dwordx4 v9, s[12:15], s25 offen lds
    s_add_u32 m0, s4, 53248
    s_add_u32 s91, s25, 65536
    buffer_load_dwordx4 v9, s[12:15], s91 offen lds
    s_add_u32 m0, s4, 57344
    s_nop 0
    buffer_load_dwordx4 v10, s[16:19], s26 offen lds
    s_add_u32 m0, s4, 61440
    s_add_u32 s91, s26, 65536
    buffer_load_dwordx4 v10, s[16:19], s91 offen lds
    s_add_u32 s24, s24, 128
    s_add_u32 s25, s25, 128
    s_add_u32 s26, s26, 128
    ds_read_b128 v[104:107], v12 offset:0
    ds_read_b128 v[108:111], v12 offset:4096
    ds_read_b128 v[112:115], v16 offset:0
    ds_read_b128 v[116:119], v20 offset:0
    s_waitcnt lgkmcnt(4)
    v_mfma_f32_32x32x16_bf16 v[24:39], v[88:91], v[96:99], v[24:39]
    v_mfma_f32_32x32x16_bf16 v[40:55], v[92:95], v[96:99], v[40:55]
    v_mfma_f32_32x32x16_bf16 v[56:71], v[88:91], v[100:103], v[56:71]
    v_mfma_f32_32x32x16_bf16 v[72:87], v[92:95], v[100:103], v[72:87]
    ds_read_b128 v[88:91], v13 offset:0
    ds_read_b128 v[92:95], v13 offset:4096
    ds_read_b128 v[96:99], v17 offset:0
    ds_read_b128 v[100:103], v21 offset:0
    s_waitcnt lgkmcnt(4)
    v_mfma_f32_32x32x16_bf16 v[24:39], v[104:107], v[112:115], v[24:39]
    v_mfma_f32_32x32x16_bf16 v[40:55], v[108:111], v[112:115], v[40:55]
    v_mfma_f32_32x32x16_bf16 v[56:71], v[104:107], v[116:119], v[56:71]
    v_mfma_f32_32x32x16_bf16 v[72:87], v[108:111], v[116:119], v[72:87]
    ds_read_b128 v[104:107], v14 offset:0
    ds_read_b128 v[108:111], v14 offset:4096
    ds_read_b128 v[112:115], v18 offset:0
    ds_read_b128 v[116:119], v22 offset:0
    s_waitcnt lgkmcnt(4)
    v_mfma_f32_32x32x16_bf16 v[24:39], v[88:91], v[96:99], v[24:39]
    v_mfma_f32_32x32x16_bf16 v[40:55], v[92:95], v[96:99], v[40:55]
    v_mfma_f32_32x32x16_bf16 v[56:71], v[88:91], v[100:103], v[56:71]
    v_mfma_f32_32x32x16_bf16 v[72:87], v[92:95], v[100:103], v[72:87]
    s_waitcnt lgkmcnt(0)
    v_mfma_f32_32x32x16_bf16 v[24:39], v[104:107], v[112:115], v[24:39]
    v_mfma_f32_32x32x16_bf16 v[40:55], v[108:111], v[112:115], v[40:55]
    v_mfma_f32_32x32x16_bf16 v[56:71], v[104:107], v[116:119], v[56:71]
    v_mfma_f32_32x32x16_bf16 v[72:87], v[108:111], v[116:119], v[72:87]
    s_waitcnt vmcnt(16)
    s_barrier
    v_add_u32 v11, 32768, v11
    v_add_u32 v12, 32768, v12
    v_add_u32 v13, 32768, v13
    v_add_u32 v14, 32768, v14
    v_add_u32 v15, 32768, v15
    v_add_u32 v16, 32768, v16
    v_add_u32 v17, 32768, v17
    v_add_u32 v18, 32768, v18
    v_add_u32 v19, 32768, v19
    v_add_u32 v20, 32768, v20
    v_add_u32 v21, 32768, v21
    v_add_u32 v22, 32768, v22
    ds_read_b128 v[88:91], v11 offset:0
    ds_read_b128 v[92:95], v11 offset:4096
    ds_read_b128 v[96:99], v15 offset:0
    ds_read_b128 v[100:103], v19 offset:0
    s_add_u32 m0, s4, 65536
    s_nop 0
    buffer_load_dwordx4 v8, s[8:11], s24 offen lds
    s_add_u32 m0, s4, 69632
    s_add_u32 s91, s24, 65536
    buffer_load_dwordx4 v8, s[8:11], s91 offen lds
    s_add_u32 m0, s4, 73728
    s_add_u32 s91, s24, 131072
    buffer_load_dwordx4 v8, s[8:11], s91 offen lds
    s_add_u32 m0, s4, 77824
    s_add_u32 s91, s24, 196608
    buffer_load_dwordx4 v8, s[8:11], s91 offen lds
    s_add_u32 m0, s4, 81920
    s_nop 0
    buffer_load_dwordx4 v9, s[12:15], s25 offen lds
    s_add_u32 m0, s4, 86016
    s_add_u32 s91, s25, 65536
    buffer_load_dwordx4 v9, s[12:15], s91 offen lds
    s_add_u32 m0, s4, 90112
    s_nop 0
    buffer_load_dwordx4 v10, s[16:19], s26 offen lds
    s_add_u32 m0, s4, 94208
    s_add_u32 s91, s26, 65536
    buffer_load_dwordx4 v10, s[16:19], s91 offen lds
    s_add_u32 s24, s24, 128
    s_add_u32 s25, s25, 128
    s_add_u32 s26, s26, 128
    ds_read_b128 v[104:107], v12 offset:0
    ds_read_b128 v[108:111], v12 offset:4096
    ds_read_b128 v[112:115], v16 offset:0
    ds_read_b128 v[116:119], v20 offset:0
    s_waitcnt lgkmcnt(4)
    v_mfma_f32_32x32x16_bf16 v[24:39], v[88:91], v[96:99], v[24:39]
    v_mfma_f32_32x32x16_bf16 v[40:55], v[92:95], v[96:99], v[40:55]
    v_mfma_f32_32x32x16_bf16 v[56:71], v[88:91], v[100:103], v[56:71]
    v_mfma_f32_32x32x16_bf16 v[72:87], v[92:95], v[100:103], v[72:87]
    ds_read_b128 v[88:91], v13 offset:0
    ds_read_b128 v[92:95], v13 offset:4096
    ds_read_b128 v[96:99], v17 offset:0
    ds_read_b128 v[100:103], v21 offset:0
    s_waitcnt lgkmcnt(4)
    v_mfma_f32_32x32x16_bf16 v[24:39], v[104:107], v[112:115], v[24:39]
    v_mfma_f32_32x32x16_bf16 v[40:55], v[108:111], v[112:115], v[40:55]
    v_mfma_f32_32x32x16_bf16 v[56:71], v[104:107], v[116:119], v[56:71]
    v_mfma_f32_32x32x16_bf16 v[72:87], v[108:111], v[116:119], v[72:87]
    ds_read_b128 v[104:107], v14 offset:0
    ds_read_b128 v[108:111], v14 offset:4096
    ds_read_b128 v[112:115], v18 offset:0
    ds_read_b128 v[116:119], v22 offset:0
    s_waitcnt lgkmcnt(4)
    v_mfma_f32_32x32x16_bf16 v[24:39], v[88:91], v[96:99], v[24:39]
    v_mfma_f32_32x32x16_bf16 v[40:55], v[92:95], v[96:99], v[40:55]
    v_mfma_f32_32x32x16_bf16 v[56:71], v[88:91], v[100:103], v[56:71]
    v_mfma_f32_32x32x16_bf16 v[72:87], v[92:95], v[100:103], v[72:87]
    s_waitcnt lgkmcnt(0)
    v_mfma_f32_32x32x16_bf16 v[24:39], v[104:107], v[112:115], v[24:39]
    v_mfma_f32_32x32x16_bf16 v[40:55], v[108:111], v[112:115], v[40:55]
    v_mfma_f32_32x32x16_bf16 v[56:71], v[104:107], v[116:119], v[56:71]
    v_mfma_f32_32x32x16_bf16 v[72:87], v[108:111], v[116:119], v[72:87]
    v_subrev_u32 v11, 98304, v11
    v_subrev_u32 v12, 98304, v12
    v_subrev_u32 v13, 98304, v13
    v_subrev_u32 v14, 98304, v14
    v_subrev_u32 v15, 98304, v15
    v_subrev_u32 v16, 98304, v16
    v_subrev_u32 v17, 98304, v17
    v_subrev_u32 v18, 98304, v18
    v_subrev_u32 v19, 98304, v19
    v_subrev_u32 v20, 98304, v20
    v_subrev_u32 v21, 98304, v21
    v_subrev_u32 v22, 98304, v22
    s_sub_u32 s92, s92, 1
    s_cmp_lg_u32 s92, 0
    s_cbranch_scc1 L_k_1
    s_waitcnt vmcnt(16)
    s_barrier
    ds_read_b128 v[88:91], v11 offset:0
    ds_read_b128 v[92:95], v11 offset:4096
    ds_read_b128 v[96:99], v15 offset:0
    ds_read_b128 v[100:103], v19 offset:0
    s_add_u32 m0, s4, 98304
    s_nop 0
    buffer_load_dwordx4 v8, s[8:11], s24 offen lds
    s_add_u32 m0, s4, 102400
    s_add_u32 s91, s24, 65536
    buffer_load_dwordx4 v8, s[8:11], s91 offen lds
    s_add_u32 m0, s4, 106496
    s_add_u32 s91, s24, 131072
    buffer_load_dwordx4 v8, s[8:11], s91 offen lds
    s_add_u32 m0, s4, 110592
    s_add_u32 s91, s24, 196608
    buffer_load_dwordx4 v8, s[8:11], s91 offen lds
    s_add_u32 m0, s4, 114688
    s_nop 0
    buffer_load_dwordx4 v9, s[12:15], s25 offen lds
    s_add_u32 m0, s4, 118784
    s_add_u32 s91, s25, 65536
    buffer_load_dwordx4 v9, s[12:15], s91 offen lds
    s_add_u32 m0, s4, 122880
    s_nop 0
    buffer_load_dwordx4 v10, s[16:19], s26 offen lds
    s_add_u32 m0, s4, 126976
    s_add_u32 s91, s26, 65536
    buffer_load_dwordx4 v10, s[16:19], s91 offen lds
    s_add_u32 s24, s24, 128
    s_add_u32 s25, s25, 128
    s_add_u32 s26, s26, 128
    ds_read_b128 v[104:107], v12 offset:0
    ds_read_b128 v[108:111], v12 offset:4096
    ds_read_b128 v[112:115], v16 offset:0
    ds_read_b128 v[116:119], v20 offset:0
    s_waitcnt lgkmcnt(4)
    v_mfma_f32_32x32x16_bf16 v[24:39], v[88:91], v[96:99], v[24:39]
    v_mfma_f32_32x32x16_bf16 v[40:55], v[92:95], v[96:99], v[40:55]
    v_mfma_f32_32x32x16_bf16 v[56:71], v[88:91], v[100:103], v[56:71]
    v_mfma_f32_32x32x16_bf16 v[72:87], v[92:95], v[100:103], v[72:87]
    ds_read_b128 v[88:91], v13 offset:0
    ds_read_b128 v[92:95], v13 offset:4096
    ds_read_b128 v[96:99], v17 offset:0
    ds_read_b128 v[100:103], v21 offset:0
    s_waitcnt lgkmcnt(4)
    v_mfma_f32_32x32x16_bf16 v[24:39], v[104:107], v[112:115], v[24:39]
    v_mfma_f32_32x32x16_bf16 v[40:55], v[108:111], v[112:115], v[40:55]
    v_mfma_f32_32x32x16_bf16 v[56:71], v[104:107], v[116:119], v[56:71]
    v_mfma_f32_32x32x16_bf16 v[72:87], v[108:111], v[116:119], v[72:87]
    ds_read_b128 v[104:107], v14 offset:0
    ds_read_b128 v[108:111], v14 offset:4096
    ds_read_b128 v[112:115], v18 offset:0
    ds_read_b128 v[116:119], v22 offset:0
    s_waitcnt lgkmcnt(4)
    v_mfma_f32_32x32x16_bf16 v[24:39], v[88:91], v[96:99], v[24:39]
    v_mfma_f32_32x32x16_bf16 v[40:55], v[92:95], v[96:99], v[40:55]
    v_mfma_f32_32x32x16_bf16 v[56:71], v[88:91], v[100:103], v[56:71]
    v_mfma_f32_32x32x16_bf16 v[72:87], v[92:95], v[100:103], v[72:87]
    s_waitcnt lgkmcnt(0)
    v_mfma_f32_32x32x16_bf16 v[24:39], v[104:107], v[112:115], v[24:39]
    v_mfma_f32_32x32x16_bf16 v[40:55], v[108:111], v[112:115], v[40:55]
    v_mfma_f32_32x32x16_bf16 v[56:71], v[104:107], v[116:119], v[56:71]
    v_mfma_f32_32x32x16_bf16 v[72:87], v[108:111], v[116:119], v[72:87]
    s_waitcnt vmcnt(16)
    s_barrier
    v_add_u32 v11, 32768, v11
    v_add_u32 v12, 32768, v12
    v_add_u32 v13, 32768, v13
    v_add_u32 v14, 32768, v14
    v_add_u32 v15, 32768, v15
    v_add_u32 v16, 32768, v16
    v_add_u32 v17, 32768, v17
    v_add_u32 v18, 32768, v18
    v_add_u32 v19, 32768, v19
    v_add_u32 v20, 32768, v20
    v_add_u32 v21, 32768, v21
    v_add_u32 v22, 32768, v22
    ds_read_b128 v[88:91], v11 offset:0
    ds_read_b128 v[92:95], v11 offset:4096
    ds_read_b128 v[96:99], v15 offset:0
    ds_read_b128 v[100:103], v19 offset:0
    ds_read_b128 v[104:107], v12 offset:0
    ds_read_b128 v[108:111], v12 offset:4096
    ds_read_b128 v[112:115], v16 offset:0
    ds_read_b128 v[116:119], v20 offset:0
    s_waitcnt lgkmcnt(4)
    v_mfma_f32_32x32x16_bf16 v[24:39], v[88:91], v[96:99], v[24:39]
    v_mfma_f32_32x32x16_bf16 v[40:55], v[92:95], v[96:99], v[40:55]
    v_mfma_f32_32x32x16_bf16 v[56:71], v[88:91], v[100:103], v[56:71]
    v_mfma_f32_32x32x16_bf16 v[72:87], v[92:95], v[100:103], v[72:87]
    ds_read_b128 v[88:91], v13 offset:0
    ds_read_b128 v[92:95], v13 offset:4096
    ds_read_b128 v[96:99], v17 offset:0
    ds_read_b128 v[100:103], v21 offset:0
    s_waitcnt lgkmcnt(4)
    v_mfma_f32_32x32x16_bf16 v[24:39], v[104:107], v[112:115], v[24:39]
    v_mfma_f32_32x32x16_bf16 v[40:55], v[108:111], v[112:115], v[40:55]
    v_mfma_f32_32x32x16_bf16 v[56:71], v[104:107], v[116:119], v[56:71]
    v_mfma_f32_32x32x16_bf16 v[72:87], v[108:111], v[116:119], v[72:87]
    ds_read_b128 v[104:107], v14 offset:0
    ds_read_b128 v[108:111], v14 offset:4096
    ds_read_b128 v[112:115], v18 offset:0
    ds_read_b128 v[116:119], v22 offset:0
    s_waitcnt lgkmcnt(4)
    v_mfma_f32_32x32x16_bf16 v[24:39], v[88:91], v[96:99], v[24:39]
    v_mfma_f32_32x32x16_bf16 v[40:55], v[92:95], v[96:99], v[40:55]
    v_mfma_f32_32x32x16_bf16 v[56:71], v[88:91], v[100:103], v[56:71]
    v_mfma_f32_32x32x16_bf16 v[72:87], v[92:95], v[100:103], v[72:87]
    s_waitcnt lgkmcnt(0)
    v_mfma_f32_32x32x16_bf16 v[24:39], v[104:107], v[112:115], v[24:39]
    v_mfma_f32_32x32x16_bf16 v[40:55], v[108:111], v[112:115], v[40:55]
    v_mfma_f32_32x32x16_bf16 v[56:71], v[104:107], v[116:119], v[56:71]
    v_mfma_f32_32x32x16_bf16 v[72:87], v[108:111], v[116:119], v[72:87]
    s_waitcnt vmcnt(8)
    s_barrier
    v_add_u32 v11, 32768, v11
    v_add_u32 v12, 32768, v12
    v_add_u32 v13, 32768, v13
    v_add_u32 v14, 32768, v14
    v_add_u32 v15, 32768, v15
    v_add_u32 v16, 32768, v16
    v_add_u32 v17, 32768, v17
    v_add_u32 v18, 32768, v18
    v_add_u32 v19, 32768, v19
    v_add_u32 v20, 32768, v20
    v_add_u32 v21, 32768, v21
    v_add_u32 v22, 32768, v22
    ds_read_b128 v[88:91], v11 offset:0
    ds_read_b128 v[92:95], v11 offset:4096
    ds_read_b128 v[96:99], v15 offset:0
    ds_read_b128 v[100:103], v19 offset:0
    ds_read_b128 v[104:107], v12 offset:0
    ds_read_b128 v[108:111], v12 offset:4096
    ds_read_b128 v[112:115], v16 offset:0
    ds_read_b128 v[116:119], v20 offset:0
    s_waitcnt lgkmcnt(4)
    v_mfma_f32_32x32x16_bf16 v[24:39], v[88:91], v[96:99], v[24:39]
    v_mfma_f32_32x32x16_bf16 v[40:55], v[92:95], v[96:99], v[40:55]
    v_mfma_f32_32x32x16_bf16 v[56:71], v[88:91], v[100:103], v[56:71]
    v_mfma_f32_32x32x16_bf16 v[72:87], v[92:95], v[100:103], v[72:87]
    ds_read_b128 v[88:91], v13 offset:0
    ds_read_b128 v[92:95], v13 offset:4096
    ds_read_b128 v[96:99], v17 offset:0
    ds_read_b128 v[100:103], v21 offset:0
    s_waitcnt lgkmcnt(4)
    v_mfma_f32_32x32x16_bf16 v[24:39], v[104:107], v[112:115], v[24:39]
    v_mfma_f32_32x32x16_bf16 v[40:55], v[108:111], v[112:115], v[40:55]
    v_mfma_f32_32x32x16_bf16 v[56:71], v[104:107], v[116:119], v[56:71]
    v_mfma_f32_32x32x16_bf16 v[72:87], v[108:111], v[116:119], v[72:87]
    ds_read_b128 v[104:107], v14 offset:0
    ds_read_b128 v[108:111], v14 offset:4096
    ds_read_b128 v[112:115], v18 offset:0
    ds_read_b128 v[116:119], v22 offset:0
    s_waitcnt lgkmcnt(4)
    v_mfma_f32_32x32x16_bf16 v[24:39], v[88:91], v[96:99], v[24:39]
    v_mfma_f32_32x32x16_bf16 v[40:55], v[92:95], v[96:99], v[40:55]
    v_mfma_f32_32x32x16_bf16 v[56:71], v[88:91], v[100:103], v[56:71]
    v_mfma_f32_32x32x16_bf16 v[72:87], v[92:95], v[100:103], v[72:87]
    s_waitcnt lgkmcnt(0)
    v_mfma_f32_32x32x16_bf16 v[24:39], v[104:107], v[112:115], v[24:39]
    v_mfma_f32_32x32x16_bf16 v[40:55], v[108:111], v[112:115], v[40:55]
    v_mfma_f32_32x32x16_bf16 v[56:71], v[104:107], v[116:119], v[56:71]
    v_mfma_f32_32x32x16_bf16 v[72:87], v[108:111], v[116:119], v[72:87]
    s_waitcnt vmcnt(0)
    s_barrier
    v_add_u32 v11, 32768, v11
    v_add_u32 v12, 32768, v12
    v_add_u32 v13, 32768, v13
    v_add_u32 v14, 32768, v14
    v_add_u32 v15, 32768, v15
    v_add_u32 v16, 32768, v16
    v_add_u32 v17, 32768, v17
    v_add_u32 v18, 32768, v18
    v_add_u32 v19, 32768, v19
    v_add_u32 v20, 32768, v20
    v_add_u32 v21, 32768, v21
    v_add_u32 v22, 32768, v22
    ds_read_b128 v[88:91], v11 offset:0
    ds_read_b128 v[92:95], v11 offset:4096
    ds_read_b128 v[96:99], v15 offset:0
    ds_read_b128 v[100:103], v19 offset:0
    ds_read_b128 v[104:107], v12 offset:0
    ds_read_b128 v[108:111], v12 offset:4096
    ds_read_b128 v[112:115], v16 offset:0
    ds_read_b128 v[116:119], v20 offset:0
    s_waitcnt lgkmcnt(4)
    v_mfma_f32_32x32x16_bf16 v[24:39], v[88:91], v[96:99], v[24:39]
    v_mfma_f32_32x32x16_bf16 v[40:55], v[92:95], v[96:99], v[40:55]
    v_mfma_f32_32x32x16_bf16 v[56:71], v[88:91], v[100:103], v[56:71]
    v_mfma_f32_32x32x16_bf16 v[72:87], v[92:95], v[100:103], v[72:87]
    ds_read_b128 v[88:91], v13 offset:0
    ds_read_b128 v[92:95], v13 offset:4096
    ds_read_b128 v[96:99], v17 offset:0
    ds_read_b128 v[100:103], v21 offset:0
    s_waitcnt lgkmcnt(4)
    v_mfma_f32_32x32x16_bf16 v[24:39], v[104:107], v[112:115], v[24:39]
    v_mfma_f32_32x32x16_bf16 v[40:55], v[108:111], v[112:115], v[40:55]
    v_mfma_f32_32x32x16_bf16 v[56:71], v[104:107], v[116:119], v[56:71]
    v_mfma_f32_32x32x16_bf16 v[72:87], v[108:111], v[116:119], v[72:87]
    ds_read_b128 v[104:107], v14 offset:0
    ds_read_b128 v[108:111], v14 offset:4096
    ds_read_b128 v[112:115], v18 offset:0
    ds_read_b128 v[116:119], v22 offset:0
    s_waitcnt lgkmcnt(4)
    v_mfma_f32_32x32x16_bf16 v[24:39], v[88:91], v[96:99], v[24:39]
    v_mfma_f32_32x32x16_bf16 v[40:55], v[92:95], v[96:99], v[40:55]
    v_mfma_f32_32x32x16_bf16 v[56:71], v[88:91], v[100:103], v[56:71]
    v_mfma_f32_32x32x16_bf16 v[72:87], v[92:95], v[100:103], v[72:87]
    s_waitcnt lgkmcnt(0)
    v_mfma_f32_32x32x16_bf16 v[24:39], v[104:107], v[112:115], v[24:39]
    v_mfma_f32_32x32x16_bf16 v[40:55], v[108:111], v[112:115], v[40:55]
    v_mfma_f32_32x32x16_bf16 v[56:71], v[104:107], v[116:119], v[56:71]
    v_mfma_f32_32x32x16_bf16 v[72:87], v[108:111], v[116:119], v[72:87]
    v_subrev_u32 v11, 98304, v11
    v_subrev_u32 v12, 98304, v12
    v_subrev_u32 v13, 98304, v13
    v_subrev_u32 v14, 98304, v14
    v_subrev_u32 v15, 98304, v15
    v_subrev_u32 v16, 98304, v16
    v_subrev_u32 v17, 98304, v17
    v_subrev_u32 v18, 98304, v18
    v_subrev_u32 v19, 98304, v19
    v_subrev_u32 v20, 98304, v20
    v_subrev_u32 v21, 98304, v21
    v_subrev_u32 v22, 98304, v22
    v_and_b32 v120, 31, v1
    v_add_u32 v120, s33, v120
    s_lshl_b32 s34, s31, 6
    v_add_u32 v120, s34, v120
    v_lshlrev_b32 v121, 4, v120
    buffer_load_dwordx4 v[122:125], v121, s[40:43], 0 offen
    v_lshrrev_b32 v121, 5, v1
    v_lshlrev_b32 v121, 2, v121
    v_add_u32 v121, s32, v121
    s_lshl_b32 s34, s30, 7
    v_add_u32 v121, s34, v121
    v_lshrrev_b32 v126, 3, v120
    v_lshl_add_u32 v121, v126, 11, v121
    v_lshlrev_b32 v121, 6, v121
    v_and_b32 v126, 7, v120
    v_lshl_add_u32 v121, v126, 3, v121
    s_nop 15
    s_waitcnt vmcnt(0)
    v_mul_f32 v126, v124, v24
    v_fma_f32 v126, -v125, v56, v126
    v_mul_f32 v127, v124, v56
    v_fma_f32 v127, v125, v24, v127
    s_mov_b32 s35, 0
    buffer_store_dwordx2 v[126:127], v121, s[20:23], s35 offen
    v_mul_f32 v128, v124, v25
    v_fma_f32 v128, -v125, v57, v128
    v_mul_f32 v129, v124, v57
    v_fma_f32 v129, v125, v25, v129
    s_mov_b32 s35, 64
    buffer_store_dwordx2 v[128:129], v121, s[20:23], s35 offen
    v_mul_f32 v130, v124, v26
    v_fma_f32 v130, -v125, v58, v130
    v_mul_f32 v131, v124, v58
    v_fma_f32 v131, v125, v26, v131
    s_mov_b32 s35, 128
    buffer_store_dwordx2 v[130:131], v121, s[20:23], s35 offen
    v_mul_f32 v132, v124, v27
    v_fma_f32 v132, -v125, v59, v132
    v_mul_f32 v133, v124, v59
    v_fma_f32 v133, v125, v27, v133
    s_mov_b32 s35, 192
    buffer_store_dwordx2 v[132:133], v121, s[20:23], s35 offen
    v_mul_f32 v126, v124, v28
    v_fma_f32 v126, -v125, v60, v126
    v_mul_f32 v127, v124, v60
    v_fma_f32 v127, v125, v28, v127
    s_mov_b32 s35, 512
    buffer_store_dwordx2 v[126:127], v121, s[20:23], s35 offen
    v_mul_f32 v128, v124, v29
    v_fma_f32 v128, -v125, v61, v128
    v_mul_f32 v129, v124, v61
    v_fma_f32 v129, v125, v29, v129
    s_mov_b32 s35, 576
    buffer_store_dwordx2 v[128:129], v121, s[20:23], s35 offen
    v_mul_f32 v130, v124, v30
    v_fma_f32 v130, -v125, v62, v130
    v_mul_f32 v131, v124, v62
    v_fma_f32 v131, v125, v30, v131
    s_mov_b32 s35, 640
    buffer_store_dwordx2 v[130:131], v121, s[20:23], s35 offen
    v_mul_f32 v132, v124, v31
    v_fma_f32 v132, -v125, v63, v132
    v_mul_f32 v133, v124, v63
    v_fma_f32 v133, v125, v31, v133
    s_mov_b32 s35, 704
    buffer_store_dwordx2 v[132:133], v121, s[20:23], s35 offen
    v_mul_f32 v126, v124, v32
    v_fma_f32 v126, -v125, v64, v126
    v_mul_f32 v127, v124, v64
    v_fma_f32 v127, v125, v32, v127
    s_mov_b32 s35, 1024
    buffer_store_dwordx2 v[126:127], v121, s[20:23], s35 offen
    v_mul_f32 v128, v124, v33
    v_fma_f32 v128, -v125, v65, v128
    v_mul_f32 v129, v124, v65
    v_fma_f32 v129, v125, v33, v129
    s_mov_b32 s35, 1088
    buffer_store_dwordx2 v[128:129], v121, s[20:23], s35 offen
    v_mul_f32 v130, v124, v34
    v_fma_f32 v130, -v125, v66, v130
    v_mul_f32 v131, v124, v66
    v_fma_f32 v131, v125, v34, v131
    s_mov_b32 s35, 1152
    buffer_store_dwordx2 v[130:131], v121, s[20:23], s35 offen
    v_mul_f32 v132, v124, v35
    v_fma_f32 v132, -v125, v67, v132
    v_mul_f32 v133, v124, v67
    v_fma_f32 v133, v125, v35, v133
    s_mov_b32 s35, 1216
    buffer_store_dwordx2 v[132:133], v121, s[20:23], s35 offen
    v_mul_f32 v126, v124, v36
    v_fma_f32 v126, -v125, v68, v126
    v_mul_f32 v127, v124, v68
    v_fma_f32 v127, v125, v36, v127
    s_mov_b32 s35, 1536
    buffer_store_dwordx2 v[126:127], v121, s[20:23], s35 offen
    v_mul_f32 v128, v124, v37
    v_fma_f32 v128, -v125, v69, v128
    v_mul_f32 v129, v124, v69
    v_fma_f32 v129, v125, v37, v129
    s_mov_b32 s35, 1600
    buffer_store_dwordx2 v[128:129], v121, s[20:23], s35 offen
    v_mul_f32 v130, v124, v38
    v_fma_f32 v130, -v125, v70, v130
    v_mul_f32 v131, v124, v70
    v_fma_f32 v131, v125, v38, v131
    s_mov_b32 s35, 1664
    buffer_store_dwordx2 v[130:131], v121, s[20:23], s35 offen
    v_mul_f32 v132, v124, v39
    v_fma_f32 v132, -v125, v71, v132
    v_mul_f32 v133, v124, v71
    v_fma_f32 v133, v125, v39, v133
    s_mov_b32 s35, 1728
    buffer_store_dwordx2 v[132:133], v121, s[20:23], s35 offen
    v_mul_f32 v126, v124, v40
    v_fma_f32 v126, -v125, v72, v126
    v_mul_f32 v127, v124, v72
    v_fma_f32 v127, v125, v40, v127
    s_mov_b32 s35, 2048
    buffer_store_dwordx2 v[126:127], v121, s[20:23], s35 offen
    v_mul_f32 v128, v124, v41
    v_fma_f32 v128, -v125, v73, v128
    v_mul_f32 v129, v124, v73
    v_fma_f32 v129, v125, v41, v129
    s_mov_b32 s35, 2112
    buffer_store_dwordx2 v[128:129], v121, s[20:23], s35 offen
    v_mul_f32 v130, v124, v42
    v_fma_f32 v130, -v125, v74, v130
    v_mul_f32 v131, v124, v74
    v_fma_f32 v131, v125, v42, v131
    s_mov_b32 s35, 2176
    buffer_store_dwordx2 v[130:131], v121, s[20:23], s35 offen
    v_mul_f32 v132, v124, v43
    v_fma_f32 v132, -v125, v75, v132
    v_mul_f32 v133, v124, v75
    v_fma_f32 v133, v125, v43, v133
    s_mov_b32 s35, 2240
    buffer_store_dwordx2 v[132:133], v121, s[20:23], s35 offen
    v_mul_f32 v126, v124, v44
    v_fma_f32 v126, -v125, v76, v126
    v_mul_f32 v127, v124, v76
    v_fma_f32 v127, v125, v44, v127
    s_mov_b32 s35, 2560
    buffer_store_dwordx2 v[126:127], v121, s[20:23], s35 offen
    v_mul_f32 v128, v124, v45
    v_fma_f32 v128, -v125, v77, v128
    v_mul_f32 v129, v124, v77
    v_fma_f32 v129, v125, v45, v129
    s_mov_b32 s35, 2624
    buffer_store_dwordx2 v[128:129], v121, s[20:23], s35 offen
    v_mul_f32 v130, v124, v46
    v_fma_f32 v130, -v125, v78, v130
    v_mul_f32 v131, v124, v78
    v_fma_f32 v131, v125, v46, v131
    s_mov_b32 s35, 2688
    buffer_store_dwordx2 v[130:131], v121, s[20:23], s35 offen
    v_mul_f32 v132, v124, v47
    v_fma_f32 v132, -v125, v79, v132
    v_mul_f32 v133, v124, v79
    v_fma_f32 v133, v125, v47, v133
    s_mov_b32 s35, 2752
    buffer_store_dwordx2 v[132:133], v121, s[20:23], s35 offen
    v_mul_f32 v126, v124, v48
    v_fma_f32 v126, -v125, v80, v126
    v_mul_f32 v127, v124, v80
    v_fma_f32 v127, v125, v48, v127
    s_mov_b32 s35, 3072
    buffer_store_dwordx2 v[126:127], v121, s[20:23], s35 offen
    v_mul_f32 v128, v124, v49
    v_fma_f32 v128, -v125, v81, v128
    v_mul_f32 v129, v124, v81
    v_fma_f32 v129, v125, v49, v129
    s_mov_b32 s35, 3136
    buffer_store_dwordx2 v[128:129], v121, s[20:23], s35 offen
    v_mul_f32 v130, v124, v50
    v_fma_f32 v130, -v125, v82, v130
    v_mul_f32 v131, v124, v82
    v_fma_f32 v131, v125, v50, v131
    s_mov_b32 s35, 3200
    buffer_store_dwordx2 v[130:131], v121, s[20:23], s35 offen
    v_mul_f32 v132, v124, v51
    v_fma_f32 v132, -v125, v83, v132
    v_mul_f32 v133, v124, v83
    v_fma_f32 v133, v125, v51, v133
    s_mov_b32 s35, 3264
    buffer_store_dwordx2 v[132:133], v121, s[20:23], s35 offen
    v_mul_f32 v126, v124, v52
    v_fma_f32 v126, -v125, v84, v126
    v_mul_f32 v127, v124, v84
    v_fma_f32 v127, v125, v52, v127
    s_mov_b32 s35, 3584
    buffer_store_dwordx2 v[126:127], v121, s[20:23], s35 offen
    v_mul_f32 v128, v124, v53
    v_fma_f32 v128, -v125, v85, v128
    v_mul_f32 v129, v124, v85
    v_fma_f32 v129, v125, v53, v129
    s_mov_b32 s35, 3648
    buffer_store_dwordx2 v[128:129], v121, s[20:23], s35 offen
    v_mul_f32 v130, v124, v54
    v_fma_f32 v130, -v125, v86, v130
    v_mul_f32 v131, v124, v86
    v_fma_f32 v131, v125, v54, v131
    s_mov_b32 s35, 3712
    buffer_store_dwordx2 v[130:131], v121, s[20:23], s35 offen
    v_mul_f32 v132, v124, v55
    v_fma_f32 v132, -v125, v87, v132
    v_mul_f32 v133, v124, v87
    v_fma_f32 v133, v125, v55, v133
    s_mov_b32 s35, 3776
    buffer_store_dwordx2 v[132:133], v121, s[20:23], s35 offen
    s_waitcnt vmcnt(0)
L_bu_done:
    s_endpgm
.globl scan_kernel
.p2align 8
.type scan_kernel,@function
scan_kernel:

    s_cmp_ge_u32 s2, 128
    s_cbranch_scc1 L_scan_done
    s_load_dwordx2 s[4:5], s[0:1], 120
    s_waitcnt lgkmcnt(0)
    s_add_u32 s6, s4, 4194304
    s_addc_u32 s7, s5, 0
    s_mov_b32 s8, s6
    s_mov_b32 s9, s7
    s_mov_b32 s10, 16384
    s_mov_b32 s11, 0x00020000
    s_add_u32 s6, s4, 8388608
    s_addc_u32 s7, s5, 0
    s_mov_b32 s12, s6
    s_mov_b32 s13, s7
    s_mov_b32 s14, 16777216
    s_mov_b32 s15, 0x00020000
    s_add_u32 s6, s4, 33554432
    s_addc_u32 s7, s5, 0
    s_mov_b32 s16, s6
    s_mov_b32 s17, s7
    s_mov_b32 s18, 8388608
    s_mov_b32 s19, 0x00020000
    v_and_b32 v1, 7, v0
    v_lshrrev_b32 v2, 3, v0
    s_lshl_b32 s3, s2, 3
    v_add_u32 v3, s3, v1
    v_lshlrev_b32 v4, 4, v3
    buffer_load_dwordx2 v[6:7], v4, s[8:11], 0 offen
    v_lshlrev_b32 v4, 11, v2
    v_lshl_add_u32 v4, v1, 3, v4
    s_lshl_b32 s21, s2, 17
    v_add_u32 v4, s21, v4
    buffer_load_dwordx2 v[16:17], v4, s[12:15], 0 offen offset:0
    buffer_load_dwordx2 v[18:19], v4, s[12:15], 0 offen offset:64
    buffer_load_dwordx2 v[20:21], v4, s[12:15], 0 offen offset:128
    buffer_load_dwordx2 v[22:23], v4, s[12:15], 0 offen offset:192
    buffer_load_dwordx2 v[24:25], v4, s[12:15], 0 offen offset:256
    buffer_load_dwordx2 v[26:27], v4, s[12:15], 0 offen offset:320
    buffer_load_dwordx2 v[28:29], v4, s[12:15], 0 offen offset:384
    buffer_load_dwordx2 v[30:31], v4, s[12:15], 0 offen offset:448
    buffer_load_dwordx2 v[32:33], v4, s[12:15], 0 offen offset:512
    buffer_load_dwordx2 v[34:35], v4, s[12:15], 0 offen offset:576
    buffer_load_dwordx2 v[36:37], v4, s[12:15], 0 offen offset:640
    buffer_load_dwordx2 v[38:39], v4, s[12:15], 0 offen offset:704
    buffer_load_dwordx2 v[40:41], v4, s[12:15], 0 offen offset:768
    buffer_load_dwordx2 v[42:43], v4, s[12:15], 0 offen offset:832
    buffer_load_dwordx2 v[44:45], v4, s[12:15], 0 offen offset:896
    buffer_load_dwordx2 v[46:47], v4, s[12:15], 0 offen offset:960
    buffer_load_dwordx2 v[48:49], v4, s[12:15], 0 offen offset:1024
    buffer_load_dwordx2 v[50:51], v4, s[12:15], 0 offen offset:1088
    buffer_load_dwordx2 v[52:53], v4, s[12:15], 0 offen offset:1152
    buffer_load_dwordx2 v[54:55], v4, s[12:15], 0 offen offset:1216
    buffer_load_dwordx2 v[56:57], v4, s[12:15], 0 offen offset:1280
    buffer_load_dwordx2 v[58:59], v4, s[12:15], 0 offen offset:1344
    buffer_load_dwordx2 v[60:61], v4, s[12:15], 0 offen offset:1408
    buffer_load_dwordx2 v[62:63], v4, s[12:15], 0 offen offset:1472
    buffer_load_dwordx2 v[64:65], v4, s[12:15], 0 offen offset:1536
    buffer_load_dwordx2 v[66:67], v4, s[12:15], 0 offen offset:1600
    buffer_load_dwordx2 v[68:69], v4, s[12:15], 0 offen offset:1664
    buffer_load_dwordx2 v[70:71], v4, s[12:15], 0 offen offset:1728
    buffer_load_dwordx2 v[72:73], v4, s[12:15], 0 offen offset:1792
    buffer_load_dwordx2 v[74:75], v4, s[12:15], 0 offen offset:1856
    buffer_load_dwordx2 v[76:77], v4, s[12:15], 0 offen offset:1920
    buffer_load_dwordx2 v[78:79], v4, s[12:15], 0 offen offset:1984
    s_waitcnt vmcnt(0)
    v_fma_f32 v18, v6, v16, v18
    v_fma_f32 v18, -v7, v17, v18
    v_fma_f32 v19, v6, v17, v19
    v_fma_f32 v19, v7, v16, v19
    v_fma_f32 v20, v6, v18, v20
    v_fma_f32 v20, -v7, v19, v20
    v_fma_f32 v21, v6, v19, v21
    v_fma_f32 v21, v7, v18, v21
    v_fma_f32 v22, v6, v20, v22
    v_fma_f32 v22, -v7, v21, v22
    v_fma_f32 v23, v6, v21, v23
    v_fma_f32 v23, v7, v20, v23
    v_fma_f32 v24, v6, v22, v24
    v_fma_f32 v24, -v7, v23, v24
    v_fma_f32 v25, v6, v23, v25
    v_fma_f32 v25, v7, v22, v25
    v_fma_f32 v26, v6, v24, v26
    v_fma_f32 v26, -v7, v25, v26
    v_fma_f32 v27, v6, v25, v27
    v_fma_f32 v27, v7, v24, v27
    v_fma_f32 v28, v6, v26, v28
    v_fma_f32 v28, -v7, v27, v28
    v_fma_f32 v29, v6, v27, v29
    v_fma_f32 v29, v7, v26, v29
    v_fma_f32 v30, v6, v28, v30
    v_fma_f32 v30, -v7, v29, v30
    v_fma_f32 v31, v6, v29, v31
    v_fma_f32 v31, v7, v28, v31
    v_fma_f32 v32, v6, v30, v32
    v_fma_f32 v32, -v7, v31, v32
    v_fma_f32 v33, v6, v31, v33
    v_fma_f32 v33, v7, v30, v33
    v_fma_f32 v34, v6, v32, v34
    v_fma_f32 v34, -v7, v33, v34
    v_fma_f32 v35, v6, v33, v35
    v_fma_f32 v35, v7, v32, v35
    v_fma_f32 v36, v6, v34, v36
    v_fma_f32 v36, -v7, v35, v36
    v_fma_f32 v37, v6, v35, v37
    v_fma_f32 v37, v7, v34, v37
    v_fma_f32 v38, v6, v36, v38
    v_fma_f32 v38, -v7, v37, v38
    v_fma_f32 v39, v6, v37, v39
    v_fma_f32 v39, v7, v36, v39
    v_fma_f32 v40, v6, v38, v40
    v_fma_f32 v40, -v7, v39, v40
    v_fma_f32 v41, v6, v39, v41
    v_fma_f32 v41, v7, v38, v41
    v_fma_f32 v42, v6, v40, v42
    v_fma_f32 v42, -v7, v41, v42
    v_fma_f32 v43, v6, v41, v43
    v_fma_f32 v43, v7, v40, v43
    v_fma_f32 v44, v6, v42, v44
    v_fma_f32 v44, -v7, v43, v44
    v_fma_f32 v45, v6, v43, v45
    v_fma_f32 v45, v7, v42, v45
    v_fma_f32 v46, v6, v44, v46
    v_fma_f32 v46, -v7, v45, v46
    v_fma_f32 v47, v6, v45, v47
    v_fma_f32 v47, v7, v44, v47
    v_fma_f32 v48, v6, v46, v48
    v_fma_f32 v48, -v7, v47, v48
    v_fma_f32 v49, v6, v47, v49
    v_fma_f32 v49, v7, v46, v49
    v_fma_f32 v50, v6, v48, v50
    v_fma_f32 v50, -v7, v49, v50
    v_fma_f32 v51, v6, v49, v51
    v_fma_f32 v51, v7, v48, v51
    v_fma_f32 v52, v6, v50, v52
    v_fma_f32 v52, -v7, v51, v52
    v_fma_f32 v53, v6, v51, v53
    v_fma_f32 v53, v7, v50, v53
    v_fma_f32 v54, v6, v52, v54
    v_fma_f32 v54, -v7, v53, v54
    v_fma_f32 v55, v6, v53, v55
    v_fma_f32 v55, v7, v52, v55
    v_fma_f32 v56, v6, v54, v56
    v_fma_f32 v56, -v7, v55, v56
    v_fma_f32 v57, v6, v55, v57
    v_fma_f32 v57, v7, v54, v57
    v_fma_f32 v58, v6, v56, v58
    v_fma_f32 v58, -v7, v57, v58
    v_fma_f32 v59, v6, v57, v59
    v_fma_f32 v59, v7, v56, v59
    v_fma_f32 v60, v6, v58, v60
    v_fma_f32 v60, -v7, v59, v60
    v_fma_f32 v61, v6, v59, v61
    v_fma_f32 v61, v7, v58, v61
    v_fma_f32 v62, v6, v60, v62
    v_fma_f32 v62, -v7, v61, v62
    v_fma_f32 v63, v6, v61, v63
    v_fma_f32 v63, v7, v60, v63
    v_fma_f32 v64, v6, v62, v64
    v_fma_f32 v64, -v7, v63, v64
    v_fma_f32 v65, v6, v63, v65
    v_fma_f32 v65, v7, v62, v65
    v_fma_f32 v66, v6, v64, v66
    v_fma_f32 v66, -v7, v65, v66
    v_fma_f32 v67, v6, v65, v67
    v_fma_f32 v67, v7, v64, v67
    v_fma_f32 v68, v6, v66, v68
    v_fma_f32 v68, -v7, v67, v68
    v_fma_f32 v69, v6, v67, v69
    v_fma_f32 v69, v7, v66, v69
    v_fma_f32 v70, v6, v68, v70
    v_fma_f32 v70, -v7, v69, v70
    v_fma_f32 v71, v6, v69, v71
    v_fma_f32 v71, v7, v68, v71
    v_fma_f32 v72, v6, v70, v72
    v_fma_f32 v72, -v7, v71, v72
    v_fma_f32 v73, v6, v71, v73
    v_fma_f32 v73, v7, v70, v73
    v_fma_f32 v74, v6, v72, v74
    v_fma_f32 v74, -v7, v73, v74
    v_fma_f32 v75, v6, v73, v75
    v_fma_f32 v75, v7, v72, v75
    v_fma_f32 v76, v6, v74, v76
    v_fma_f32 v76, -v7, v75, v76
    v_fma_f32 v77, v6, v75, v77
    v_fma_f32 v77, v7, v74, v77
    v_fma_f32 v78, v6, v76, v78
    v_fma_f32 v78, -v7, v77, v78
    v_fma_f32 v79, v6, v77, v79
    v_fma_f32 v79, v7, v76, v79
    v_lshlrev_b32 v5, 3, v0
    ds_write_b64 v5, v[78:79]
    v_mov_b32 v8, v6
    v_mov_b32 v9, v7
    v_mul_f32 v10, v8, v8
    v_fma_f32 v10, -v9, v9, v10
    v_mul_f32 v11, v8, v9
    v_fma_f32 v9, v9, v8, v11
    v_mov_b32 v8, v10
    v_mul_f32 v10, v8, v8
    v_fma_f32 v10, -v9, v9, v10
    v_mul_f32 v11, v8, v9
    v_fma_f32 v9, v9, v8, v11
    v_mov_b32 v8, v10
    v_mul_f32 v10, v8, v8
    v_fma_f32 v10, -v9, v9, v10
    v_mul_f32 v11, v8, v9
    v_fma_f32 v9, v9, v8, v11
    v_mov_b32 v8, v10
    v_mul_f32 v10, v8, v8
    v_fma_f32 v10, -v9, v9, v10
    v_mul_f32 v11, v8, v9
    v_fma_f32 v9, v9, v8, v11
    v_mov_b32 v8, v10
    v_mul_f32 v10, v8, v8
    v_fma_f32 v10, -v9, v9, v10
    v_mul_f32 v11, v8, v9
    v_fma_f32 v9, v9, v8, v11
    v_mov_b32 v8, v10
    s_waitcnt lgkmcnt(0)
    s_barrier
    v_cmp_gt_u32 vcc, 8, v0
    s_and_saveexec_b64 s[22:23], vcc
    s_cbranch_execz L_scan_c
    ds_read_b64 v[84:85], v5 offset:0
    ds_read_b64 v[86:87], v5 offset:64
    ds_read_b64 v[88:89], v5 offset:128
    ds_read_b64 v[90:91], v5 offset:192
    ds_read_b64 v[92:93], v5 offset:256
    ds_read_b64 v[94:95], v5 offset:320
    ds_read_b64 v[96:97], v5 offset:384
    ds_read_b64 v[98:99], v5 offset:448
    ds_read_b64 v[100:101], v5 offset:512
    ds_read_b64 v[102:103], v5 offset:576
    ds_read_b64 v[104:105], v5 offset:640
    ds_read_b64 v[106:107], v5 offset:704
    ds_read_b64 v[108:109], v5 offset:768
    ds_read_b64 v[110:111], v5 offset:832
    ds_read_b64 v[112:113], v5 offset:896
    ds_read_b64 v[114:115], v5 offset:960
    ds_read_b64 v[116:117], v5 offset:1024
    ds_read_b64 v[118:119], v5 offset:1088
    ds_read_b64 v[120:121], v5 offset:1152
    ds_read_b64 v[122:123], v5 offset:1216
    ds_read_b64 v[124:125], v5 offset:1280
    ds_read_b64 v[126:127], v5 offset:1344
    ds_read_b64 v[128:129], v5 offset:1408
    ds_read_b64 v[130:131], v5 offset:1472
    ds_read_b64 v[132:133], v5 offset:1536
    ds_read_b64 v[134:135], v5 offset:1600
    ds_read_b64 v[136:137], v5 offset:1664
    ds_read_b64 v[138:139], v5 offset:1728
    ds_read_b64 v[140:141], v5 offset:1792
    ds_read_b64 v[142:143], v5 offset:1856
    ds_read_b64 v[144:145], v5 offset:1920
    ds_read_b64 v[146:147], v5 offset:1984
    ds_read_b64 v[148:149], v5 offset:2048
    ds_read_b64 v[150:151], v5 offset:2112
    ds_read_b64 v[152:153], v5 offset:2176
    ds_read_b64 v[154:155], v5 offset:2240
    ds_read_b64 v[156:157], v5 offset:2304
    ds_read_b64 v[158:159], v5 offset:2368
    ds_read_b64 v[160:161], v5 offset:2432
    ds_read_b64 v[162:163], v5 offset:2496
    ds_read_b64 v[164:165], v5 offset:2560
    ds_read_b64 v[166:167], v5 offset:2624
    ds_read_b64 v[168:169], v5 offset:2688
    ds_read_b64 v[170:171], v5 offset:2752
    ds_read_b64 v[172:173], v5 offset:2816
    ds_read_b64 v[174:175], v5 offset:2880
    ds_read_b64 v[176:177], v5 offset:2944
    ds_read_b64 v[178:179], v5 offset:3008
    ds_read_b64 v[180:181], v5 offset:3072
    ds_read_b64 v[182:183], v5 offset:3136
    ds_read_b64 v[184:185], v5 offset:3200
    ds_read_b64 v[186:187], v5 offset:3264
    ds_read_b64 v[188:189], v5 offset:3328
    ds_read_b64 v[190:191], v5 offset:3392
    ds_read_b64 v[192:193], v5 offset:3456
    ds_read_b64 v[194:195], v5 offset:3520
    ds_read_b64 v[196:197], v5 offset:3584
    ds_read_b64 v[198:199], v5 offset:3648
    ds_read_b64 v[200:201], v5 offset:3712
    ds_read_b64 v[202:203], v5 offset:3776
    ds_read_b64 v[204:205], v5 offset:3840
    ds_read_b64 v[206:207], v5 offset:3904
    ds_read_b64 v[208:209], v5 offset:3968
    ds_read_b64 v[210:211], v5 offset:4032
    v_mov_b32 v12, 0
    v_mov_b32 v13, 0
    s_waitcnt lgkmcnt(0)
    ds_write_b64 v5, v[12:13] offset:4096
    v_mul_f32 v10, v8, v12
    v_fma_f32 v10, -v9, v13, v10
    v_mul_f32 v11, v8, v13
    v_fma_f32 v13, v9, v12, v11
    v_mov_b32 v12, v10
    v_add_f32 v12, v12, v84
    v_add_f32 v13, v13, v85
    ds_write_b64 v5, v[12:13] offset:4160
    v_mul_f32 v10, v8, v12
    v_fma_f32 v10, -v9, v13, v10
    v_mul_f32 v11, v8, v13
    v_fma_f32 v13, v9, v12, v11
    v_mov_b32 v12, v10
    v_add_f32 v12, v12, v86
    v_add_f32 v13, v13, v87
    ds_write_b64 v5, v[12:13] offset:4224
    v_mul_f32 v10, v8, v12
    v_fma_f32 v10, -v9, v13, v10
    v_mul_f32 v11, v8, v13
    v_fma_f32 v13, v9, v12, v11
    v_mov_b32 v12, v10
    v_add_f32 v12, v12, v88
    v_add_f32 v13, v13, v89
    ds_write_b64 v5, v[12:13] offset:4288
    v_mul_f32 v10, v8, v12
    v_fma_f32 v10, -v9, v13, v10
    v_mul_f32 v11, v8, v13
    v_fma_f32 v13, v9, v12, v11
    v_mov_b32 v12, v10
    v_add_f32 v12, v12, v90
    v_add_f32 v13, v13, v91
    ds_write_b64 v5, v[12:13] offset:4352
    v_mul_f32 v10, v8, v12
    v_fma_f32 v10, -v9, v13, v10
    v_mul_f32 v11, v8, v13
    v_fma_f32 v13, v9, v12, v11
    v_mov_b32 v12, v10
    v_add_f32 v12, v12, v92
    v_add_f32 v13, v13, v93
    ds_write_b64 v5, v[12:13] offset:4416
    v_mul_f32 v10, v8, v12
    v_fma_f32 v10, -v9, v13, v10
    v_mul_f32 v11, v8, v13
    v_fma_f32 v13, v9, v12, v11
    v_mov_b32 v12, v10
    v_add_f32 v12, v12, v94
    v_add_f32 v13, v13, v95
    ds_write_b64 v5, v[12:13] offset:4480
    v_mul_f32 v10, v8, v12
    v_fma_f32 v10, -v9, v13, v10
    v_mul_f32 v11, v8, v13
    v_fma_f32 v13, v9, v12, v11
    v_mov_b32 v12, v10
    v_add_f32 v12, v12, v96
    v_add_f32 v13, v13, v97
    ds_write_b64 v5, v[12:13] offset:4544
    v_mul_f32 v10, v8, v12
    v_fma_f32 v10, -v9, v13, v10
    v_mul_f32 v11, v8, v13
    v_fma_f32 v13, v9, v12, v11
    v_mov_b32 v12, v10
    v_add_f32 v12, v12, v98
    v_add_f32 v13, v13, v99
    ds_write_b64 v5, v[12:13] offset:4608
    v_mul_f32 v10, v8, v12
    v_fma_f32 v10, -v9, v13, v10
    v_mul_f32 v11, v8, v13
    v_fma_f32 v13, v9, v12, v11
    v_mov_b32 v12, v10
    v_add_f32 v12, v12, v100
    v_add_f32 v13, v13, v101
    ds_write_b64 v5, v[12:13] offset:4672
    v_mul_f32 v10, v8, v12
    v_fma_f32 v10, -v9, v13, v10
    v_mul_f32 v11, v8, v13
    v_fma_f32 v13, v9, v12, v11
    v_mov_b32 v12, v10
    v_add_f32 v12, v12, v102
    v_add_f32 v13, v13, v103
    ds_write_b64 v5, v[12:13] offset:4736
    v_mul_f32 v10, v8, v12
    v_fma_f32 v10, -v9, v13, v10
    v_mul_f32 v11, v8, v13
    v_fma_f32 v13, v9, v12, v11
    v_mov_b32 v12, v10
    v_add_f32 v12, v12, v104
    v_add_f32 v13, v13, v105
    ds_write_b64 v5, v[12:13] offset:4800
    v_mul_f32 v10, v8, v12
    v_fma_f32 v10, -v9, v13, v10
    v_mul_f32 v11, v8, v13
    v_fma_f32 v13, v9, v12, v11
    v_mov_b32 v12, v10
    v_add_f32 v12, v12, v106
    v_add_f32 v13, v13, v107
    ds_write_b64 v5, v[12:13] offset:4864
    v_mul_f32 v10, v8, v12
    v_fma_f32 v10, -v9, v13, v10
    v_mul_f32 v11, v8, v13
    v_fma_f32 v13, v9, v12, v11
    v_mov_b32 v12, v10
    v_add_f32 v12, v12, v108
    v_add_f32 v13, v13, v109
    ds_write_b64 v5, v[12:13] offset:4928
    v_mul_f32 v10, v8, v12
    v_fma_f32 v10, -v9, v13, v10
    v_mul_f32 v11, v8, v13
    v_fma_f32 v13, v9, v12, v11
    v_mov_b32 v12, v10
    v_add_f32 v12, v12, v110
    v_add_f32 v13, v13, v111
    ds_write_b64 v5, v[12:13] offset:4992
    v_mul_f32 v10, v8, v12
    v_fma_f32 v10, -v9, v13, v10
    v_mul_f32 v11, v8, v13
    v_fma_f32 v13, v9, v12, v11
    v_mov_b32 v12, v10
    v_add_f32 v12, v12, v112
    v_add_f32 v13, v13, v113
    ds_write_b64 v5, v[12:13] offset:5056
    v_mul_f32 v10, v8, v12
    v_fma_f32 v10, -v9, v13, v10
    v_mul_f32 v11, v8, v13
    v_fma_f32 v13, v9, v12, v11
    v_mov_b32 v12, v10
    v_add_f32 v12, v12, v114
    v_add_f32 v13, v13, v115
    ds_write_b64 v5, v[12:13] offset:5120
    v_mul_f32 v10, v8, v12
    v_fma_f32 v10, -v9, v13, v10
    v_mul_f32 v11, v8, v13
    v_fma_f32 v13, v9, v12, v11
    v_mov_b32 v12, v10
    v_add_f32 v12, v12, v116
    v_add_f32 v13, v13, v117
    ds_write_b64 v5, v[12:13] offset:5184
    v_mul_f32 v10, v8, v12
    v_fma_f32 v10, -v9, v13, v10
    v_mul_f32 v11, v8, v13
    v_fma_f32 v13, v9, v12, v11
    v_mov_b32 v12, v10
    v_add_f32 v12, v12, v118
    v_add_f32 v13, v13, v119
    ds_write_b64 v5, v[12:13] offset:5248
    v_mul_f32 v10, v8, v12
    v_fma_f32 v10, -v9, v13, v10
    v_mul_f32 v11, v8, v13
    v_fma_f32 v13, v9, v12, v11
    v_mov_b32 v12, v10
    v_add_f32 v12, v12, v120
    v_add_f32 v13, v13, v121
    ds_write_b64 v5, v[12:13] offset:5312
    v_mul_f32 v10, v8, v12
    v_fma_f32 v10, -v9, v13, v10
    v_mul_f32 v11, v8, v13
    v_fma_f32 v13, v9, v12, v11
    v_mov_b32 v12, v10
    v_add_f32 v12, v12, v122
    v_add_f32 v13, v13, v123
    ds_write_b64 v5, v[12:13] offset:5376
    v_mul_f32 v10, v8, v12
    v_fma_f32 v10, -v9, v13, v10
    v_mul_f32 v11, v8, v13
    v_fma_f32 v13, v9, v12, v11
    v_mov_b32 v12, v10
    v_add_f32 v12, v12, v124
    v_add_f32 v13, v13, v125
    ds_write_b64 v5, v[12:13] offset:5440
    v_mul_f32 v10, v8, v12
    v_fma_f32 v10, -v9, v13, v10
    v_mul_f32 v11, v8, v13
    v_fma_f32 v13, v9, v12, v11
    v_mov_b32 v12, v10
    v_add_f32 v12, v12, v126
    v_add_f32 v13, v13, v127
    ds_write_b64 v5, v[12:13] offset:5504
    v_mul_f32 v10, v8, v12
    v_fma_f32 v10, -v9, v13, v10
    v_mul_f32 v11, v8, v13
    v_fma_f32 v13, v9, v12, v11
    v_mov_b32 v12, v10
    v_add_f32 v12, v12, v128
    v_add_f32 v13, v13, v129
    ds_write_b64 v5, v[12:13] offset:5568
    v_mul_f32 v10, v8, v12
    v_fma_f32 v10, -v9, v13, v10
    v_mul_f32 v11, v8, v13
    v_fma_f32 v13, v9, v12, v11
    v_mov_b32 v12, v10
    v_add_f32 v12, v12, v130
    v_add_f32 v13, v13, v131
    ds_write_b64 v5, v[12:13] offset:5632
    v_mul_f32 v10, v8, v12
    v_fma_f32 v10, -v9, v13, v10
    v_mul_f32 v11, v8, v13
    v_fma_f32 v13, v9, v12, v11
    v_mov_b32 v12, v10
    v_add_f32 v12, v12, v132
    v_add_f32 v13, v13, v133
    ds_write_b64 v5, v[12:13] offset:5696
    v_mul_f32 v10, v8, v12
    v_fma_f32 v10, -v9, v13, v10
    v_mul_f32 v11, v8, v13
    v_fma_f32 v13, v9, v12, v11
    v_mov_b32 v12, v10
    v_add_f32 v12, v12, v134
    v_add_f32 v13, v13, v135
    ds_write_b64 v5, v[12:13] offset:5760
    v_mul_f32 v10, v8, v12
    v_fma_f32 v10, -v9, v13, v10
    v_mul_f32 v11, v8, v13
    v_fma_f32 v13, v9, v12, v11
    v_mov_b32 v12, v10
    v_add_f32 v12, v12, v136
    v_add_f32 v13, v13, v137
    ds_write_b64 v5, v[12:13] offset:5824
    v_mul_f32 v10, v8, v12
    v_fma_f32 v10, -v9, v13, v10
    v_mul_f32 v11, v8, v13
    v_fma_f32 v13, v9, v12, v11
    v_mov_b32 v12, v10
    v_add_f32 v12, v12, v138
    v_add_f32 v13, v13, v139
    ds_write_b64 v5, v[12:13] offset:5888
    v_mul_f32 v10, v8, v12
    v_fma_f32 v10, -v9, v13, v10
    v_mul_f32 v11, v8, v13
    v_fma_f32 v13, v9, v12, v11
    v_mov_b32 v12, v10
    v_add_f32 v12, v12, v140
    v_add_f32 v13, v13, v141
    ds_write_b64 v5, v[12:13] offset:5952
    v_mul_f32 v10, v8, v12
    v_fma_f32 v10, -v9, v13, v10
    v_mul_f32 v11, v8, v13
    v_fma_f32 v13, v9, v12, v11
    v_mov_b32 v12, v10
    v_add_f32 v12, v12, v142
    v_add_f32 v13, v13, v143
    ds_write_b64 v5, v[12:13] offset:6016
    v_mul_f32 v10, v8, v12
    v_fma_f32 v10, -v9, v13, v10
    v_mul_f32 v11, v8, v13
    v_fma_f32 v13, v9, v12, v11
    v_mov_b32 v12, v10
    v_add_f32 v12, v12, v144
    v_add_f32 v13, v13, v145
    ds_write_b64 v5, v[12:13] offset:6080
    v_mul_f32 v10, v8, v12
    v_fma_f32 v10, -v9, v13, v10
    v_mul_f32 v11, v8, v13
    v_fma_f32 v13, v9, v12, v11
    v_mov_b32 v12, v10
    v_add_f32 v12, v12, v146
    v_add_f32 v13, v13, v147
    ds_write_b64 v5, v[12:13] offset:6144
    v_mul_f32 v10, v8, v12
    v_fma_f32 v10, -v9, v13, v10
    v_mul_f32 v11, v8, v13
    v_fma_f32 v13, v9, v12, v11
    v_mov_b32 v12, v10
    v_add_f32 v12, v12, v148
    v_add_f32 v13, v13, v149
    ds_write_b64 v5, v[12:13] offset:6208
    v_mul_f32 v10, v8, v12
    v_fma_f32 v10, -v9, v13, v10
    v_mul_f32 v11, v8, v13
    v_fma_f32 v13, v9, v12, v11
    v_mov_b32 v12, v10
    v_add_f32 v12, v12, v150
    v_add_f32 v13, v13, v151
    ds_write_b64 v5, v[12:13] offset:6272
    v_mul_f32 v10, v8, v12
    v_fma_f32 v10, -v9, v13, v10
    v_mul_f32 v11, v8, v13
    v_fma_f32 v13, v9, v12, v11
    v_mov_b32 v12, v10
    v_add_f32 v12, v12, v152
    v_add_f32 v13, v13, v153
    ds_write_b64 v5, v[12:13] offset:6336
    v_mul_f32 v10, v8, v12
    v_fma_f32 v10, -v9, v13, v10
    v_mul_f32 v11, v8, v13
    v_fma_f32 v13, v9, v12, v11
    v_mov_b32 v12, v10
    v_add_f32 v12, v12, v154
    v_add_f32 v13, v13, v155
    ds_write_b64 v5, v[12:13] offset:6400
    v_mul_f32 v10, v8, v12
    v_fma_f32 v10, -v9, v13, v10
    v_mul_f32 v11, v8, v13
    v_fma_f32 v13, v9, v12, v11
    v_mov_b32 v12, v10
    v_add_f32 v12, v12, v156
    v_add_f32 v13, v13, v157
    ds_write_b64 v5, v[12:13] offset:6464
    v_mul_f32 v10, v8, v12
    v_fma_f32 v10, -v9, v13, v10
    v_mul_f32 v11, v8, v13
    v_fma_f32 v13, v9, v12, v11
    v_mov_b32 v12, v10
    v_add_f32 v12, v12, v158
    v_add_f32 v13, v13, v159
    ds_write_b64 v5, v[12:13] offset:6528
    v_mul_f32 v10, v8, v12
    v_fma_f32 v10, -v9, v13, v10
    v_mul_f32 v11, v8, v13
    v_fma_f32 v13, v9, v12, v11
    v_mov_b32 v12, v10
    v_add_f32 v12, v12, v160
    v_add_f32 v13, v13, v161
    ds_write_b64 v5, v[12:13] offset:6592
    v_mul_f32 v10, v8, v12
    v_fma_f32 v10, -v9, v13, v10
    v_mul_f32 v11, v8, v13
    v_fma_f32 v13, v9, v12, v11
    v_mov_b32 v12, v10
    v_add_f32 v12, v12, v162
    v_add_f32 v13, v13, v163
    ds_write_b64 v5, v[12:13] offset:6656
    v_mul_f32 v10, v8, v12
    v_fma_f32 v10, -v9, v13, v10
    v_mul_f32 v11, v8, v13
    v_fma_f32 v13, v9, v12, v11
    v_mov_b32 v12, v10
    v_add_f32 v12, v12, v164
    v_add_f32 v13, v13, v165
    ds_write_b64 v5, v[12:13] offset:6720
    v_mul_f32 v10, v8, v12
    v_fma_f32 v10, -v9, v13, v10
    v_mul_f32 v11, v8, v13
    v_fma_f32 v13, v9, v12, v11
    v_mov_b32 v12, v10
    v_add_f32 v12, v12, v166
    v_add_f32 v13, v13, v167
    ds_write_b64 v5, v[12:13] offset:6784
    v_mul_f32 v10, v8, v12
    v_fma_f32 v10, -v9, v13, v10
    v_mul_f32 v11, v8, v13
    v_fma_f32 v13, v9, v12, v11
    v_mov_b32 v12, v10
    v_add_f32 v12, v12, v168
    v_add_f32 v13, v13, v169
    ds_write_b64 v5, v[12:13] offset:6848
    v_mul_f32 v10, v8, v12
    v_fma_f32 v10, -v9, v13, v10
    v_mul_f32 v11, v8, v13
    v_fma_f32 v13, v9, v12, v11
    v_mov_b32 v12, v10
    v_add_f32 v12, v12, v170
    v_add_f32 v13, v13, v171
    ds_write_b64 v5, v[12:13] offset:6912
    v_mul_f32 v10, v8, v12
    v_fma_f32 v10, -v9, v13, v10
    v_mul_f32 v11, v8, v13
    v_fma_f32 v13, v9, v12, v11
    v_mov_b32 v12, v10
    v_add_f32 v12, v12, v172
    v_add_f32 v13, v13, v173
    ds_write_b64 v5, v[12:13] offset:6976
    v_mul_f32 v10, v8, v12
    v_fma_f32 v10, -v9, v13, v10
    v_mul_f32 v11, v8, v13
    v_fma_f32 v13, v9, v12, v11
    v_mov_b32 v12, v10
    v_add_f32 v12, v12, v174
    v_add_f32 v13, v13, v175
    ds_write_b64 v5, v[12:13] offset:7040
    v_mul_f32 v10, v8, v12
    v_fma_f32 v10, -v9, v13, v10
    v_mul_f32 v11, v8, v13
    v_fma_f32 v13, v9, v12, v11
    v_mov_b32 v12, v10
    v_add_f32 v12, v12, v176
    v_add_f32 v13, v13, v177
    ds_write_b64 v5, v[12:13] offset:7104
    v_mul_f32 v10, v8, v12
    v_fma_f32 v10, -v9, v13, v10
    v_mul_f32 v11, v8, v13
    v_fma_f32 v13, v9, v12, v11
    v_mov_b32 v12, v10
    v_add_f32 v12, v12, v178
    v_add_f32 v13, v13, v179
    ds_write_b64 v5, v[12:13] offset:7168
    v_mul_f32 v10, v8, v12
    v_fma_f32 v10, -v9, v13, v10
    v_mul_f32 v11, v8, v13
    v_fma_f32 v13, v9, v12, v11
    v_mov_b32 v12, v10
    v_add_f32 v12, v12, v180
    v_add_f32 v13, v13, v181
    ds_write_b64 v5, v[12:13] offset:7232
    v_mul_f32 v10, v8, v12
    v_fma_f32 v10, -v9, v13, v10
    v_mul_f32 v11, v8, v13
    v_fma_f32 v13, v9, v12, v11
    v_mov_b32 v12, v10
    v_add_f32 v12, v12, v182
    v_add_f32 v13, v13, v183
    ds_write_b64 v5, v[12:13] offset:7296
    v_mul_f32 v10, v8, v12
    v_fma_f32 v10, -v9, v13, v10
    v_mul_f32 v11, v8, v13
    v_fma_f32 v13, v9, v12, v11
    v_mov_b32 v12, v10
    v_add_f32 v12, v12, v184
    v_add_f32 v13, v13, v185
    ds_write_b64 v5, v[12:13] offset:7360
    v_mul_f32 v10, v8, v12
    v_fma_f32 v10, -v9, v13, v10
    v_mul_f32 v11, v8, v13
    v_fma_f32 v13, v9, v12, v11
    v_mov_b32 v12, v10
    v_add_f32 v12, v12, v186
    v_add_f32 v13, v13, v187
    ds_write_b64 v5, v[12:13] offset:7424
    v_mul_f32 v10, v8, v12
    v_fma_f32 v10, -v9, v13, v10
    v_mul_f32 v11, v8, v13
    v_fma_f32 v13, v9, v12, v11
    v_mov_b32 v12, v10
    v_add_f32 v12, v12, v188
    v_add_f32 v13, v13, v189
    ds_write_b64 v5, v[12:13] offset:7488
    v_mul_f32 v10, v8, v12
    v_fma_f32 v10, -v9, v13, v10
    v_mul_f32 v11, v8, v13
    v_fma_f32 v13, v9, v12, v11
    v_mov_b32 v12, v10
    v_add_f32 v12, v12, v190
    v_add_f32 v13, v13, v191
    ds_write_b64 v5, v[12:13] offset:7552
    v_mul_f32 v10, v8, v12
    v_fma_f32 v10, -v9, v13, v10
    v_mul_f32 v11, v8, v13
    v_fma_f32 v13, v9, v12, v11
    v_mov_b32 v12, v10
    v_add_f32 v12, v12, v192
    v_add_f32 v13, v13, v193
    ds_write_b64 v5, v[12:13] offset:7616
    v_mul_f32 v10, v8, v12
    v_fma_f32 v10, -v9, v13, v10
    v_mul_f32 v11, v8, v13
    v_fma_f32 v13, v9, v12, v11
    v_mov_b32 v12, v10
    v_add_f32 v12, v12, v194
    v_add_f32 v13, v13, v195
    ds_write_b64 v5, v[12:13] offset:7680
    v_mul_f32 v10, v8, v12
    v_fma_f32 v10, -v9, v13, v10
    v_mul_f32 v11, v8, v13
    v_fma_f32 v13, v9, v12, v11
    v_mov_b32 v12, v10
    v_add_f32 v12, v12, v196
    v_add_f32 v13, v13, v197
    ds_write_b64 v5, v[12:13] offset:7744
    v_mul_f32 v10, v8, v12
    v_fma_f32 v10, -v9, v13, v10
    v_mul_f32 v11, v8, v13
    v_fma_f32 v13, v9, v12, v11
    v_mov_b32 v12, v10
    v_add_f32 v12, v12, v198
    v_add_f32 v13, v13, v199
    ds_write_b64 v5, v[12:13] offset:7808
    v_mul_f32 v10, v8, v12
    v_fma_f32 v10, -v9, v13, v10
    v_mul_f32 v11, v8, v13
    v_fma_f32 v13, v9, v12, v11
    v_mov_b32 v12, v10
    v_add_f32 v12, v12, v200
    v_add_f32 v13, v13, v201
    ds_write_b64 v5, v[12:13] offset:7872
    v_mul_f32 v10, v8, v12
    v_fma_f32 v10, -v9, v13, v10
    v_mul_f32 v11, v8, v13
    v_fma_f32 v13, v9, v12, v11
    v_mov_b32 v12, v10
    v_add_f32 v12, v12, v202
    v_add_f32 v13, v13, v203
    ds_write_b64 v5, v[12:13] offset:7936
    v_mul_f32 v10, v8, v12
    v_fma_f32 v10, -v9, v13, v10
    v_mul_f32 v11, v8, v13
    v_fma_f32 v13, v9, v12, v11
    v_mov_b32 v12, v10
    v_add_f32 v12, v12, v204
    v_add_f32 v13, v13, v205
    ds_write_b64 v5, v[12:13] offset:8000
    v_mul_f32 v10, v8, v12
    v_fma_f32 v10, -v9, v13, v10
    v_mul_f32 v11, v8, v13
    v_fma_f32 v13, v9, v12, v11
    v_mov_b32 v12, v10
    v_add_f32 v12, v12, v206
    v_add_f32 v13, v13, v207
    ds_write_b64 v5, v[12:13] offset:8064
    v_mul_f32 v10, v8, v12
    v_fma_f32 v10, -v9, v13, v10
    v_mul_f32 v11, v8, v13
    v_fma_f32 v13, v9, v12, v11
    v_mov_b32 v12, v10
    v_add_f32 v12, v12, v208
    v_add_f32 v13, v13, v209
    ds_write_b64 v5, v[12:13] offset:8128
    v_mul_f32 v10, v8, v12
    v_fma_f32 v10, -v9, v13, v10
    v_mul_f32 v11, v8, v13
    v_fma_f32 v13, v9, v12, v11
    v_mov_b32 v12, v10
    v_add_f32 v12, v12, v210
    v_add_f32 v13, v13, v211
    s_waitcnt lgkmcnt(0)
L_scan_c:
    s_or_b64 exec, exec, s[22:23]
    s_barrier
    ds_read_b64 v[12:13], v5 offset:4096
    s_waitcnt lgkmcnt(0)
    v_mul_f32 v10, v6, v12
    v_fma_f32 v10, -v7, v13, v10
    v_mul_f32 v11, v6, v13
    v_fma_f32 v13, v7, v12, v11
    v_mov_b32 v12, v10
    v_add_f32 v16, v16, v12
    v_add_f32 v17, v17, v13
    v_mul_f32 v10, v6, v12
    v_fma_f32 v10, -v7, v13, v10
    v_mul_f32 v11, v6, v13
    v_fma_f32 v13, v7, v12, v11
    v_mov_b32 v12, v10
    v_add_f32 v18, v18, v12
    v_add_f32 v19, v19, v13
    v_mul_f32 v10, v6, v12
    v_fma_f32 v10, -v7, v13, v10
    v_mul_f32 v11, v6, v13
    v_fma_f32 v13, v7, v12, v11
    v_mov_b32 v12, v10
    v_add_f32 v20, v20, v12
    v_add_f32 v21, v21, v13
    v_mul_f32 v10, v6, v12
    v_fma_f32 v10, -v7, v13, v10
    v_mul_f32 v11, v6, v13
    v_fma_f32 v13, v7, v12, v11
    v_mov_b32 v12, v10
    v_add_f32 v22, v22, v12
    v_add_f32 v23, v23, v13
    v_mul_f32 v10, v6, v12
    v_fma_f32 v10, -v7, v13, v10
    v_mul_f32 v11, v6, v13
    v_fma_f32 v13, v7, v12, v11
    v_mov_b32 v12, v10
    v_add_f32 v24, v24, v12
    v_add_f32 v25, v25, v13
    v_mul_f32 v10, v6, v12
    v_fma_f32 v10, -v7, v13, v10
    v_mul_f32 v11, v6, v13
    v_fma_f32 v13, v7, v12, v11
    v_mov_b32 v12, v10
    v_add_f32 v26, v26, v12
    v_add_f32 v27, v27, v13
    v_mul_f32 v10, v6, v12
    v_fma_f32 v10, -v7, v13, v10
    v_mul_f32 v11, v6, v13
    v_fma_f32 v13, v7, v12, v11
    v_mov_b32 v12, v10
    v_add_f32 v28, v28, v12
    v_add_f32 v29, v29, v13
    v_mul_f32 v10, v6, v12
    v_fma_f32 v10, -v7, v13, v10
    v_mul_f32 v11, v6, v13
    v_fma_f32 v13, v7, v12, v11
    v_mov_b32 v12, v10
    v_add_f32 v30, v30, v12
    v_add_f32 v31, v31, v13
    v_mul_f32 v10, v6, v12
    v_fma_f32 v10, -v7, v13, v10
    v_mul_f32 v11, v6, v13
    v_fma_f32 v13, v7, v12, v11
    v_mov_b32 v12, v10
    v_add_f32 v32, v32, v12
    v_add_f32 v33, v33, v13
    v_mul_f32 v10, v6, v12
    v_fma_f32 v10, -v7, v13, v10
    v_mul_f32 v11, v6, v13
    v_fma_f32 v13, v7, v12, v11
    v_mov_b32 v12, v10
    v_add_f32 v34, v34, v12
    v_add_f32 v35, v35, v13
    v_mul_f32 v10, v6, v12
    v_fma_f32 v10, -v7, v13, v10
    v_mul_f32 v11, v6, v13
    v_fma_f32 v13, v7, v12, v11
    v_mov_b32 v12, v10
    v_add_f32 v36, v36, v12
    v_add_f32 v37, v37, v13
    v_mul_f32 v10, v6, v12
    v_fma_f32 v10, -v7, v13, v10
    v_mul_f32 v11, v6, v13
    v_fma_f32 v13, v7, v12, v11
    v_mov_b32 v12, v10
    v_add_f32 v38, v38, v12
    v_add_f32 v39, v39, v13
    v_mul_f32 v10, v6, v12
    v_fma_f32 v10, -v7, v13, v10
    v_mul_f32 v11, v6, v13
    v_fma_f32 v13, v7, v12, v11
    v_mov_b32 v12, v10
    v_add_f32 v40, v40, v12
    v_add_f32 v41, v41, v13
    v_mul_f32 v10, v6, v12
    v_fma_f32 v10, -v7, v13, v10
    v_mul_f32 v11, v6, v13
    v_fma_f32 v13, v7, v12, v11
    v_mov_b32 v12, v10
    v_add_f32 v42, v42, v12
    v_add_f32 v43, v43, v13
    v_mul_f32 v10, v6, v12
    v_fma_f32 v10, -v7, v13, v10
    v_mul_f32 v11, v6, v13
    v_fma_f32 v13, v7, v12, v11
    v_mov_b32 v12, v10
    v_add_f32 v44, v44, v12
    v_add_f32 v45, v45, v13
    v_mul_f32 v10, v6, v12
    v_fma_f32 v10, -v7, v13, v10
    v_mul_f32 v11, v6, v13
    v_fma_f32 v13, v7, v12, v11
    v_mov_b32 v12, v10
    v_add_f32 v46, v46, v12
    v_add_f32 v47, v47, v13
    v_mul_f32 v10, v6, v12
    v_fma_f32 v10, -v7, v13, v10
    v_mul_f32 v11, v6, v13
    v_fma_f32 v13, v7, v12, v11
    v_mov_b32 v12, v10
    v_add_f32 v48, v48, v12
    v_add_f32 v49, v49, v13
    v_mul_f32 v10, v6, v12
    v_fma_f32 v10, -v7, v13, v10
    v_mul_f32 v11, v6, v13
    v_fma_f32 v13, v7, v12, v11
    v_mov_b32 v12, v10
    v_add_f32 v50, v50, v12
    v_add_f32 v51, v51, v13
    v_mul_f32 v10, v6, v12
    v_fma_f32 v10, -v7, v13, v10
    v_mul_f32 v11, v6, v13
    v_fma_f32 v13, v7, v12, v11
    v_mov_b32 v12, v10
    v_add_f32 v52, v52, v12
    v_add_f32 v53, v53, v13
    v_mul_f32 v10, v6, v12
    v_fma_f32 v10, -v7, v13, v10
    v_mul_f32 v11, v6, v13
    v_fma_f32 v13, v7, v12, v11
    v_mov_b32 v12, v10
    v_add_f32 v54, v54, v12
    v_add_f32 v55, v55, v13
    v_mul_f32 v10, v6, v12
    v_fma_f32 v10, -v7, v13, v10
    v_mul_f32 v11, v6, v13
    v_fma_f32 v13, v7, v12, v11
    v_mov_b32 v12, v10
    v_add_f32 v56, v56, v12
    v_add_f32 v57, v57, v13
    v_mul_f32 v10, v6, v12
    v_fma_f32 v10, -v7, v13, v10
    v_mul_f32 v11, v6, v13
    v_fma_f32 v13, v7, v12, v11
    v_mov_b32 v12, v10
    v_add_f32 v58, v58, v12
    v_add_f32 v59, v59, v13
    v_mul_f32 v10, v6, v12
    v_fma_f32 v10, -v7, v13, v10
    v_mul_f32 v11, v6, v13
    v_fma_f32 v13, v7, v12, v11
    v_mov_b32 v12, v10
    v_add_f32 v60, v60, v12
    v_add_f32 v61, v61, v13
    v_mul_f32 v10, v6, v12
    v_fma_f32 v10, -v7, v13, v10
    v_mul_f32 v11, v6, v13
    v_fma_f32 v13, v7, v12, v11
    v_mov_b32 v12, v10
    v_add_f32 v62, v62, v12
    v_add_f32 v63, v63, v13
    v_mul_f32 v10, v6, v12
    v_fma_f32 v10, -v7, v13, v10
    v_mul_f32 v11, v6, v13
    v_fma_f32 v13, v7, v12, v11
    v_mov_b32 v12, v10
    v_add_f32 v64, v64, v12
    v_add_f32 v65, v65, v13
    v_mul_f32 v10, v6, v12
    v_fma_f32 v10, -v7, v13, v10
    v_mul_f32 v11, v6, v13
    v_fma_f32 v13, v7, v12, v11
    v_mov_b32 v12, v10
    v_add_f32 v66, v66, v12
    v_add_f32 v67, v67, v13
    v_mul_f32 v10, v6, v12
    v_fma_f32 v10, -v7, v13, v10
    v_mul_f32 v11, v6, v13
    v_fma_f32 v13, v7, v12, v11
    v_mov_b32 v12, v10
    v_add_f32 v68, v68, v12
    v_add_f32 v69, v69, v13
    v_mul_f32 v10, v6, v12
    v_fma_f32 v10, -v7, v13, v10
    v_mul_f32 v11, v6, v13
    v_fma_f32 v13, v7, v12, v11
    v_mov_b32 v12, v10
    v_add_f32 v70, v70, v12
    v_add_f32 v71, v71, v13
    v_mul_f32 v10, v6, v12
    v_fma_f32 v10, -v7, v13, v10
    v_mul_f32 v11, v6, v13
    v_fma_f32 v13, v7, v12, v11
    v_mov_b32 v12, v10
    v_add_f32 v72, v72, v12
    v_add_f32 v73, v73, v13
    v_mul_f32 v10, v6, v12
    v_fma_f32 v10, -v7, v13, v10
    v_mul_f32 v11, v6, v13
    v_fma_f32 v13, v7, v12, v11
    v_mov_b32 v12, v10
    v_add_f32 v74, v74, v12
    v_add_f32 v75, v75, v13
    v_mul_f32 v10, v6, v12
    v_fma_f32 v10, -v7, v13, v10
    v_mul_f32 v11, v6, v13
    v_fma_f32 v13, v7, v12, v11
    v_mov_b32 v12, v10
    v_add_f32 v76, v76, v12
    v_add_f32 v77, v77, v13
    v_mul_f32 v10, v6, v12
    v_fma_f32 v10, -v7, v13, v10
    v_mul_f32 v11, v6, v13
    v_fma_f32 v13, v7, v12, v11
    v_mov_b32 v12, v10
    v_add_f32 v78, v78, v12
    v_add_f32 v79, v79, v13
    v_cvt_pk_bf16_f32 v84, v16, v18
    v_cvt_pk_bf16_f32 v100, -v17, -v19
    v_cvt_pk_bf16_f32 v85, v20, v22
    v_cvt_pk_bf16_f32 v101, -v21, -v23
    v_cvt_pk_bf16_f32 v86, v24, v26
    v_cvt_pk_bf16_f32 v102, -v25, -v27
    v_cvt_pk_bf16_f32 v87, v28, v30
    v_cvt_pk_bf16_f32 v103, -v29, -v31
    v_cvt_pk_bf16_f32 v88, v32, v34
    v_cvt_pk_bf16_f32 v104, -v33, -v35
    v_cvt_pk_bf16_f32 v89, v36, v38
    v_cvt_pk_bf16_f32 v105, -v37, -v39
    v_cvt_pk_bf16_f32 v90, v40, v42
    v_cvt_pk_bf16_f32 v106, -v41, -v43
    v_cvt_pk_bf16_f32 v91, v44, v46
    v_cvt_pk_bf16_f32 v107, -v45, -v47
    v_cvt_pk_bf16_f32 v92, v48, v50
    v_cvt_pk_bf16_f32 v108, -v49, -v51
    v_cvt_pk_bf16_f32 v93, v52, v54
    v_cvt_pk_bf16_f32 v109, -v53, -v55
    v_cvt_pk_bf16_f32 v94, v56, v58
    v_cvt_pk_bf16_f32 v110, -v57, -v59
    v_cvt_pk_bf16_f32 v95, v60, v62
    v_cvt_pk_bf16_f32 v111, -v61, -v63
    v_cvt_pk_bf16_f32 v96, v64, v66
    v_cvt_pk_bf16_f32 v112, -v65, -v67
    v_cvt_pk_bf16_f32 v97, v68, v70
    v_cvt_pk_bf16_f32 v113, -v69, -v71
    v_cvt_pk_bf16_f32 v98, v72, v74
    v_cvt_pk_bf16_f32 v114, -v73, -v75
    v_cvt_pk_bf16_f32 v99, v76, v78
    v_cvt_pk_bf16_f32 v115, -v77, -v79
    v_lshlrev_b32 v4, 12, v3
    v_lshl_add_u32 v4, v2, 6, v4
    buffer_store_dwordx4 v[84:87], v4, s[16:19], 0 offen offset:0
    buffer_store_dwordx4 v[88:91], v4, s[16:19], 0 offen offset:16
    buffer_store_dwordx4 v[92:95], v4, s[16:19], 0 offen offset:32
    buffer_store_dwordx4 v[96:99], v4, s[16:19], 0 offen offset:48
    s_mov_b32 s20, 4194304
    buffer_store_dwordx4 v[100:103], v4, s[16:19], s20 offen offset:0
    buffer_store_dwordx4 v[104:107], v4, s[16:19], s20 offen offset:16
    buffer_store_dwordx4 v[108:111], v4, s[16:19], s20 offen offset:32
    buffer_store_dwordx4 v[112:115], v4, s[16:19], s20 offen offset:48
    s_waitcnt vmcnt(0)
L_scan_done:
    s_endpgm
.globl ffn1_kernel
.p2align 8
.type ffn1_kernel,@function
ffn1_kernel:

    s_cmp_ge_u32 s2, 224
    s_cbranch_scc1 L_ffn1_done
    s_load_dwordx2 s[4:5], s[0:1], 80
    s_load_dwordx2 s[6:7], s[0:1], 88
    s_load_dwordx2 s[28:29], s[0:1], 120
    s_waitcnt lgkmcnt(0)
    s_mov_b32 s8, s28
    s_mov_b32 s9, s29
    s_mov_b32 s10, 4194304
    s_mov_b32 s11, 0x00020000
    s_mov_b32 s12, s4
    s_mov_b32 s13, s5
    s_mov_b32 s14, 7340032
    s_mov_b32 s15, 0x00020000
    s_mov_b32 s16, s6
    s_mov_b32 s17, s7
    s_mov_b32 s18, 7340032
    s_mov_b32 s19, 0x00020000
    s_add_u32 s28, s28, 50331648
    s_addc_u32 s29, s29, 0
    s_mov_b32 s20, s28
    s_mov_b32 s21, s29
    s_mov_b32 s22, 14680064
    s_mov_b32 s23, 0x00020000
    v_lshrrev_b32 v1, 6, v0
    s_nop 0
    v_readfirstlane_b32 s3, v1
    v_and_b32 v1, 63, v0
    s_lshl_b32 s4, s3, 10
    s_and_b32 s30, s2, 7
    s_lshr_b32 s31, s2, 3
    s_mul_i32 s24, s30, 256*2048
    s_lshl_b32 s25, s31, 8
    s_mov_b32 s26, s25
    s_and_b32 s32, s3, 3
    s_lshl_b32 s32, s32, 6
    s_lshr_b32 s33, s3, 2
    s_lshl_b32 s33, s33, 6
    v_lshrrev_b32 v2, 3, v1
    v_and_b32 v3, 7, v1
    v_lshrrev_b32 v4, 1, v2
    s_and_b32 s90, s3, 1
    s_lshl_b32 s90, s90, 2
    v_add_u32 v4, s90, v4
    v_xor_b32 v3, v3, v4
    v_lshlrev_b32 v3, 4, v3
    s_lshl_b32 s90, s3, 3
    v_add_u32 v2, s90, v2
    s_mov_b32 s90, 2048
    v_mul_lo_u32 v2, v2, s90
    v_add_u32 v8, v2, v3
    v_lshrrev_b32 v2, 4, v1
    v_and_b32 v3, 15, v1
    v_and_b32 v4, 3, v2
    v_lshlrev_b32 v4, 2, v4
    v_xor_b32 v3, v3, v4
    v_lshlrev_b32 v3, 4, v3
    s_mul_i32 s90, s3, 4
    v_add_u32 v2, s90, v2
    s_mov_b32 s90, 7168
    v_mul_lo_u32 v2, v2, s90
    v_add_u32 v9, v2, v3
    v_lshrrev_b32 v2, 4, v1
    v_and_b32 v3, 15, v1
    v_and_b32 v4, 3, v2
    v_lshlrev_b32 v4, 2, v4
    v_xor_b32 v3, v3, v4
    v_lshlrev_b32 v3, 4, v3
    s_mul_i32 s90, s3, 4
    v_add_u32 v2, s90, v2
    s_mov_b32 s90, 7168
    v_mul_lo_u32 v2, v2, s90
    v_add_u32 v10, v2, v3
    v_and_b32 v2, 31, v1
    v_lshrrev_b32 v3, 5, v1
    v_lshrrev_b32 v4, 1, v2
    v_and_b32 v4, 7, v4
    v_add_u32 v2, s32, v2
    v_lshlrev_b32 v2, 7, v2
    v_add_u32 v11, 0, v3
    v_xor_b32 v11, v11, v4
    v_lshlrev_b32 v11, 4, v11
    v_add_u32 v11, v11, v2
    v_add_u32 v12, 2, v3
    v_xor_b32 v12, v12, v4
    v_lshlrev_b32 v12, 4, v12
    v_add_u32 v12, v12, v2
    v_add_u32 v13, 4, v3
    v_xor_b32 v13, v13, v4
    v_lshlrev_b32 v13, 4, v13
    v_add_u32 v13, v13, v2
    v_add_u32 v14, 6, v3
    v_xor_b32 v14, v14, v4
    v_lshlrev_b32 v14, 4, v14
    v_add_u32 v14, v14, v2
    v_and_b32 v2, 15, v1
    v_lshrrev_b32 v3, 2, v2
    v_and_b32 v2, 3, v2
    v_lshlrev_b32 v2, 3, v2
    v_lshrrev_b32 v4, 4, v1
    v_and_b32 v4, 1, v4
    v_lshl_add_u32 v2, v4, 5, v2
    s_lshl_b32 s90, s33, 1
    s_add_u32 s90, s90, 0
    v_add_u32 v15, s90, v2
    v_lshlrev_b32 v4, 6, v3
    v_xor_b32 v15, v15, v4
    v_lshrrev_b32 v4, 5, v1
    v_lshl_add_u32 v4, v4, 3, v3
    v_lshlrev_b32 v4, 8, v4
    v_add_u32 v15, v15, v4
    v_add_u32 v15, 32768, v15
    s_lshl_b32 s90, s33, 1
    s_add_u32 s90, s90, 64
    v_add_u32 v16, s90, v2
    v_lshlrev_b32 v4, 6, v3
    v_xor_b32 v16, v16, v4
    v_lshrrev_b32 v4, 5, v1
    v_lshl_add_u32 v4, v4, 3, v3
    v_lshlrev_b32 v4, 8, v4
    v_add_u32 v16, v16, v4
    v_add_u32 v16, 32768, v16
    v_and_b32 v2, 15, v1
    v_lshrrev_b32 v3, 2, v2
    v_and_b32 v2, 3, v2
    v_lshlrev_b32 v2, 3, v2
    v_lshrrev_b32 v4, 4, v1
    v_and_b32 v4, 1, v4
    v_lshl_add_u32 v2, v4, 5, v2
    s_lshl_b32 s90, s33, 1
    s_add_u32 s90, s90, 0
    v_add_u32 v17, s90, v2
    v_lshlrev_b32 v4, 6, v3
    v_xor_b32 v17, v17, v4
    v_lshrrev_b32 v4, 5, v1
    v_lshl_add_u32 v4, v4, 3, v3
    v_lshlrev_b32 v4, 8, v4
    v_add_u32 v17, v17, v4
    v_add_u32 v17, 49152, v17
    s_lshl_b32 s90, s33, 1
    s_add_u32 s90, s90, 64
    v_add_u32 v18, s90, v2
    v_lshlrev_b32 v4, 6, v3
    v_xor_b32 v18, v18, v4
    v_lshrrev_b32 v4, 5, v1
    v_lshl_add_u32 v4, v4, 3, v3
    v_lshlrev_b32 v4, 8, v4
    v_add_u32 v18, v18, v4
    v_add_u32 v18, 49152, v18
    v_mov_b32 v20, 0
    v_mov_b32 v21, 0
    v_mov_b32 v22, 0
    v_mov_b32 v23, 0
    v_mov_b32 v24, 0
    v_mov_b32 v25, 0
    v_mov_b32 v26, 0
    v_mov_b32 v27, 0
    v_mov_b32 v28, 0
    v_mov_b32 v29, 0
    v_mov_b32 v30, 0
    v_mov_b32 v31, 0
    v_mov_b32 v32, 0
    v_mov_b32 v33, 0
    v_mov_b32 v34, 0
    v_mov_b32 v35, 0
    v_mov_b32 v36, 0
    v_mov_b32 v37, 0
    v_mov_b32 v38, 0
    v_mov_b32 v39, 0
    v_mov_b32 v40, 0
    v_mov_b32 v41, 0
    v_mov_b32 v42, 0
    v_mov_b32 v43, 0
    v_mov_b32 v44, 0
    v_mov_b32 v45, 0
    v_mov_b32 v46, 0
    v_mov_b32 v47, 0
    v_mov_b32 v48, 0
    v_mov_b32 v49, 0
    v_mov_b32 v50, 0
    v_mov_b32 v51, 0
    v_mov_b32 v52, 0
    v_mov_b32 v53, 0
    v_mov_b32 v54, 0
    v_mov_b32 v55, 0
    v_mov_b32 v56, 0
    v_mov_b32 v57, 0
    v_mov_b32 v58, 0
    v_mov_b32 v59, 0
    v_mov_b32 v60, 0
    v_mov_b32 v61, 0
    v_mov_b32 v62, 0
    v_mov_b32 v63, 0
    v_mov_b32 v64, 0
    v_mov_b32 v65, 0
    v_mov_b32 v66, 0
    v_mov_b32 v67, 0
    v_mov_b32 v68, 0
    v_mov_b32 v69, 0
    v_mov_b32 v70, 0
    v_mov_b32 v71, 0
    v_mov_b32 v72, 0
    v_mov_b32 v73, 0
    v_mov_b32 v74, 0
    v_mov_b32 v75, 0
    v_mov_b32 v76, 0
    v_mov_b32 v77, 0
    v_mov_b32 v78, 0
    v_mov_b32 v79, 0
    v_mov_b32 v80, 0
    v_mov_b32 v81, 0
    v_mov_b32 v82, 0
    v_mov_b32 v83, 0
    v_mov_b32 v84, 0
    v_mov_b32 v85, 0
    v_mov_b32 v86, 0
    v_mov_b32 v87, 0
    v_mov_b32 v88, 0
    v_mov_b32 v89, 0
    v_mov_b32 v90, 0
    v_mov_b32 v91, 0
    v_mov_b32 v92, 0
    v_mov_b32 v93, 0
    v_mov_b32 v94, 0
    v_mov_b32 v95, 0
    v_mov_b32 v96, 0
    v_mov_b32 v97, 0
    v_mov_b32 v98, 0
    v_mov_b32 v99, 0
    v_mov_b32 v100, 0
    v_mov_b32 v101, 0
    v_mov_b32 v102, 0
    v_mov_b32 v103, 0
    v_mov_b32 v104, 0
    v_mov_b32 v105, 0
    v_mov_b32 v106, 0
    v_mov_b32 v107, 0
    v_mov_b32 v108, 0
    v_mov_b32 v109, 0
    v_mov_b32 v110, 0
    v_mov_b32 v111, 0
    v_mov_b32 v112, 0
    v_mov_b32 v113, 0
    v_mov_b32 v114, 0
    v_mov_b32 v115, 0
    v_mov_b32 v116, 0
    v_mov_b32 v117, 0
    v_mov_b32 v118, 0
    v_mov_b32 v119, 0
    v_mov_b32 v120, 0
    v_mov_b32 v121, 0
    v_mov_b32 v122, 0
    v_mov_b32 v123, 0
    v_mov_b32 v124, 0
    v_mov_b32 v125, 0
    v_mov_b32 v126, 0
    v_mov_b32 v127, 0
    v_mov_b32 v128, 0
    v_mov_b32 v129, 0
    v_mov_b32 v130, 0
    v_mov_b32 v131, 0
    v_mov_b32 v132, 0
    v_mov_b32 v133, 0
    v_mov_b32 v134, 0
    v_mov_b32 v135, 0
    v_mov_b32 v136, 0
    v_mov_b32 v137, 0
    v_mov_b32 v138, 0
    v_mov_b32 v139, 0
    v_mov_b32 v140, 0
    v_mov_b32 v141, 0
    v_mov_b32 v142, 0
    v_mov_b32 v143, 0
    v_mov_b32 v144, 0
    v_mov_b32 v145, 0
    v_mov_b32 v146, 0
    v_mov_b32 v147, 0
    s_add_u32 m0, s4, 0
    s_nop 0
    buffer_load_dwordx4 v8, s[8:11], s24 offen lds
    s_add_u32 m0, s4, 8192
    s_add_u32 s91, s24, 131072
    buffer_load_dwordx4 v8, s[8:11], s91 offen lds
    s_add_u32 m0, s4, 16384
    s_add_u32 s91, s24, 262144
    buffer_load_dwordx4 v8, s[8:11], s91 offen lds
    s_add_u32 m0, s4, 24576
    s_add_u32 s91, s24, 393216
    buffer_load_dwordx4 v8, s[8:11], s91 offen lds
    s_add_u32 m0, s4, 32768
    s_nop 0
    buffer_load_dwordx4 v9, s[12:15], s25 offen lds
    s_add_u32 m0, s4, 40960
    s_add_u32 s91, s25, 229376
    buffer_load_dwordx4 v9, s[12:15], s91 offen lds
    s_add_u32 m0, s4, 49152
    s_nop 0
    buffer_load_dwordx4 v10, s[16:19], s26 offen lds
    s_add_u32 m0, s4, 57344
    s_add_u32 s91, s26, 229376
    buffer_load_dwordx4 v10, s[16:19], s91 offen lds
    s_add_u32 s24, s24, 128
    s_add_u32 s25, s25, 458752
    s_add_u32 s26, s26, 458752
    s_mov_b32 s92, 7
L_k_2:
    s_waitcnt vmcnt(0)
    s_barrier
    ds_read_b128 v[148:151], v11 offset:0
    ds_read_b128 v[152:155], v11 offset:4096
    ds_read_b64_tr_b16 v[156:157], v15 offset:0
    ds_read_b64_tr_b16 v[158:159], v15 offset:1024
    ds_read_b64_tr_b16 v[160:161], v16 offset:0
    ds_read_b64_tr_b16 v[162:163], v16 offset:1024
    ds_read_b64_tr_b16 v[164:165], v17 offset:0
    ds_read_b64_tr_b16 v[166:167], v17 offset:1024
    ds_read_b64_tr_b16 v[168:169], v18 offset:0
    ds_read_b64_tr_b16 v[170:171], v18 offset:1024
    s_add_u32 m0, s4, 65536
    s_nop 0
    buffer_load_dwordx4 v8, s[8:11], s24 offen lds
    s_add_u32 m0, s4, 73728
    s_add_u32 s91, s24, 131072
    buffer_load_dwordx4 v8, s[8:11], s91 offen lds
    s_add_u32 m0, s4, 81920
    s_add_u32 s91, s24, 262144
    buffer_load_dwordx4 v8, s[8:11], s91 offen lds
    s_add_u32 m0, s4, 90112
    s_add_u32 s91, s24, 393216
    buffer_load_dwordx4 v8, s[8:11], s91 offen lds
    s_add_u32 m0, s4, 98304
    s_nop 0
    buffer_load_dwordx4 v9, s[12:15], s25 offen lds
    s_add_u32 m0, s4, 106496
    s_add_u32 s91, s25, 229376
    buffer_load_dwordx4 v9, s[12:15], s91 offen lds
    s_add_u32 m0, s4, 114688
    s_nop 0
    buffer_load_dwordx4 v10, s[16:19], s26 offen lds
    s_add_u32 m0, s4, 122880
    s_add_u32 s91, s26, 229376
    buffer_load_dwordx4 v10, s[16:19], s91 offen lds
    s_add_u32 s24, s24, 128
    s_add_u32 s25, s25, 458752
    s_add_u32 s26, s26, 458752
    ds_read_b128 v[172:175], v12 offset:0
    ds_read_b128 v[176:179], v12 offset:4096
    ds_read_b64_tr_b16 v[180:181], v15 offset:4096
    ds_read_b64_tr_b16 v[182:183], v15 offset:5120
    ds_read_b64_tr_b16 v[184:185], v16 offset:4096
    ds_read_b64_tr_b16 v[186:187], v16 offset:5120
    ds_read_b64_tr_b16 v[188:189], v17 offset:4096
    ds_read_b64_tr_b16 v[190:191], v17 offset:5120
    ds_read_b64_tr_b16 v[192:193], v18 offset:4096
    ds_read_b64_tr_b16 v[194:195], v18 offset:5120
    s_waitcnt lgkmcnt(10)
    v_mfma_f32_32x32x16_bf16 v[20:35], v[148:151], v[156:159], v[20:35]
    v_mfma_f32_32x32x16_bf16 v[36:51], v[148:151], v[160:163], v[36:51]
    v_mfma_f32_32x32x16_bf16 v[52:67], v[152:155], v[156:159], v[52:67]
    v_mfma_f32_32x32x16_bf16 v[68:83], v[152:155], v[160:163], v[68:83]
    v_mfma_f32_32x32x16_bf16 v[84:99], v[148:151], v[164:167], v[84:99]
    v_mfma_f32_32x32x16_bf16 v[100:115], v[148:151], v[168:171], v[100:115]
    v_mfma_f32_32x32x16_bf16 v[116:131], v[152:155], v[164:167], v[116:131]
    v_mfma_f32_32x32x16_bf16 v[132:147], v[152:155], v[168:171], v[132:147]
    ds_read_b128 v[148:151], v13 offset:0
    ds_read_b128 v[152:155], v13 offset:4096
    ds_read_b64_tr_b16 v[156:157], v15 offset:8192
    ds_read_b64_tr_b16 v[158:159], v15 offset:9216
    ds_read_b64_tr_b16 v[160:161], v16 offset:8192
    ds_read_b64_tr_b16 v[162:163], v16 offset:9216
    ds_read_b64_tr_b16 v[164:165], v17 offset:8192
    ds_read_b64_tr_b16 v[166:167], v17 offset:9216
    ds_read_b64_tr_b16 v[168:169], v18 offset:8192
    ds_read_b64_tr_b16 v[170:171], v18 offset:9216
    s_waitcnt lgkmcnt(10)
    v_mfma_f32_32x32x16_bf16 v[20:35], v[172:175], v[180:183], v[20:35]
    v_mfma_f32_32x32x16_bf16 v[36:51], v[172:175], v[184:187], v[36:51]
    v_mfma_f32_32x32x16_bf16 v[52:67], v[176:179], v[180:183], v[52:67]
    v_mfma_f32_32x32x16_bf16 v[68:83], v[176:179], v[184:187], v[68:83]
    v_mfma_f32_32x32x16_bf16 v[84:99], v[172:175], v[188:191], v[84:99]
    v_mfma_f32_32x32x16_bf16 v[100:115], v[172:175], v[192:195], v[100:115]
    v_mfma_f32_32x32x16_bf16 v[116:131], v[176:179], v[188:191], v[116:131]
    v_mfma_f32_32x32x16_bf16 v[132:147], v[176:179], v[192:195], v[132:147]
    ds_read_b128 v[172:175], v14 offset:0
    ds_read_b128 v[176:179], v14 offset:4096
    ds_read_b64_tr_b16 v[180:181], v15 offset:12288
    ds_read_b64_tr_b16 v[182:183], v15 offset:13312
    ds_read_b64_tr_b16 v[184:185], v16 offset:12288
    ds_read_b64_tr_b16 v[186:187], v16 offset:13312
    ds_read_b64_tr_b16 v[188:189], v17 offset:12288
    ds_read_b64_tr_b16 v[190:191], v17 offset:13312
    ds_read_b64_tr_b16 v[192:193], v18 offset:12288
    ds_read_b64_tr_b16 v[194:195], v18 offset:13312
    s_waitcnt lgkmcnt(10)
    v_mfma_f32_32x32x16_bf16 v[20:35], v[148:151], v[156:159], v[20:35]
    v_mfma_f32_32x32x16_bf16 v[36:51], v[148:151], v[160:163], v[36:51]
    v_mfma_f32_32x32x16_bf16 v[52:67], v[152:155], v[156:159], v[52:67]
    v_mfma_f32_32x32x16_bf16 v[68:83], v[152:155], v[160:163], v[68:83]
    v_mfma_f32_32x32x16_bf16 v[84:99], v[148:151], v[164:167], v[84:99]
    v_mfma_f32_32x32x16_bf16 v[100:115], v[148:151], v[168:171], v[100:115]
    v_mfma_f32_32x32x16_bf16 v[116:131], v[152:155], v[164:167], v[116:131]
    v_mfma_f32_32x32x16_bf16 v[132:147], v[152:155], v[168:171], v[132:147]
    s_waitcnt lgkmcnt(0)
    v_mfma_f32_32x32x16_bf16 v[20:35], v[172:175], v[180:183], v[20:35]
    v_mfma_f32_32x32x16_bf16 v[36:51], v[172:175], v[184:187], v[36:51]
    v_mfma_f32_32x32x16_bf16 v[52:67], v[176:179], v[180:183], v[52:67]
    v_mfma_f32_32x32x16_bf16 v[68:83], v[176:179], v[184:187], v[68:83]
    v_mfma_f32_32x32x16_bf16 v[84:99], v[172:175], v[188:191], v[84:99]
    v_mfma_f32_32x32x16_bf16 v[100:115], v[172:175], v[192:195], v[100:115]
    v_mfma_f32_32x32x16_bf16 v[116:131], v[176:179], v[188:191], v[116:131]
    v_mfma_f32_32x32x16_bf16 v[132:147], v[176:179], v[192:195], v[132:147]
    s_waitcnt vmcnt(0)
    s_barrier
    v_add_u32 v11, 65536, v11
    v_add_u32 v12, 65536, v12
    v_add_u32 v13, 65536, v13
    v_add_u32 v14, 65536, v14
    v_add_u32 v15, 65536, v15
    v_add_u32 v16, 65536, v16
    v_add_u32 v17, 65536, v17
    v_add_u32 v18, 65536, v18
    ds_read_b128 v[148:151], v11 offset:0
    ds_read_b128 v[152:155], v11 offset:4096
    ds_read_b64_tr_b16 v[156:157], v15 offset:0
    ds_read_b64_tr_b16 v[158:159], v15 offset:1024
    ds_read_b64_tr_b16 v[160:161], v16 offset:0
    ds_read_b64_tr_b16 v[162:163], v16 offset:1024
    ds_read_b64_tr_b16 v[164:165], v17 offset:0
    ds_read_b64_tr_b16 v[166:167], v17 offset:1024
    ds_read_b64_tr_b16 v[168:169], v18 offset:0
    ds_read_b64_tr_b16 v[170:171], v18 offset:1024
    s_add_u32 m0, s4, 0
    s_nop 0
    buffer_load_dwordx4 v8, s[8:11], s24 offen lds
    s_add_u32 m0, s4, 8192
    s_add_u32 s91, s24, 131072
    buffer_load_dwordx4 v8, s[8:11], s91 offen lds
    s_add_u32 m0, s4, 16384
    s_add_u32 s91, s24, 262144
    buffer_load_dwordx4 v8, s[8:11], s91 offen lds
    s_add_u32 m0, s4, 24576
    s_add_u32 s91, s24, 393216
    buffer_load_dwordx4 v8, s[8:11], s91 offen lds
    s_add_u32 m0, s4, 32768
    s_nop 0
    buffer_load_dwordx4 v9, s[12:15], s25 offen lds
    s_add_u32 m0, s4, 40960
    s_add_u32 s91, s25, 229376
    buffer_load_dwordx4 v9, s[12:15], s91 offen lds
    s_add_u32 m0, s4, 49152
    s_nop 0
    buffer_load_dwordx4 v10, s[16:19], s26 offen lds
    s_add_u32 m0, s4, 57344
    s_add_u32 s91, s26, 229376
    buffer_load_dwordx4 v10, s[16:19], s91 offen lds
    s_add_u32 s24, s24, 128
    s_add_u32 s25, s25, 458752
    s_add_u32 s26, s26, 458752
    ds_read_b128 v[172:175], v12 offset:0
    ds_read_b128 v[176:179], v12 offset:4096
    ds_read_b64_tr_b16 v[180:181], v15 offset:4096
    ds_read_b64_tr_b16 v[182:183], v15 offset:5120
    ds_read_b64_tr_b16 v[184:185], v16 offset:4096
    ds_read_b64_tr_b16 v[186:187], v16 offset:5120
    ds_read_b64_tr_b16 v[188:189], v17 offset:4096
    ds_read_b64_tr_b16 v[190:191], v17 offset:5120
    ds_read_b64_tr_b16 v[192:193], v18 offset:4096
    ds_read_b64_tr_b16 v[194:195], v18 offset:5120
    s_waitcnt lgkmcnt(10)
    v_mfma_f32_32x32x16_bf16 v[20:35], v[148:151], v[156:159], v[20:35]
    v_mfma_f32_32x32x16_bf16 v[36:51], v[148:151], v[160:163], v[36:51]
    v_mfma_f32_32x32x16_bf16 v[52:67], v[152:155], v[156:159], v[52:67]
    v_mfma_f32_32x32x16_bf16 v[68:83], v[152:155], v[160:163], v[68:83]
    v_mfma_f32_32x32x16_bf16 v[84:99], v[148:151], v[164:167], v[84:99]
    v_mfma_f32_32x32x16_bf16 v[100:115], v[148:151], v[168:171], v[100:115]
    v_mfma_f32_32x32x16_bf16 v[116:131], v[152:155], v[164:167], v[116:131]
    v_mfma_f32_32x32x16_bf16 v[132:147], v[152:155], v[168:171], v[132:147]
    ds_read_b128 v[148:151], v13 offset:0
    ds_read_b128 v[152:155], v13 offset:4096
    ds_read_b64_tr_b16 v[156:157], v15 offset:8192
    ds_read_b64_tr_b16 v[158:159], v15 offset:9216
    ds_read_b64_tr_b16 v[160:161], v16 offset:8192
    ds_read_b64_tr_b16 v[162:163], v16 offset:9216
    ds_read_b64_tr_b16 v[164:165], v17 offset:8192
    ds_read_b64_tr_b16 v[166:167], v17 offset:9216
    ds_read_b64_tr_b16 v[168:169], v18 offset:8192
    ds_read_b64_tr_b16 v[170:171], v18 offset:9216
    s_waitcnt lgkmcnt(10)
    v_mfma_f32_32x32x16_bf16 v[20:35], v[172:175], v[180:183], v[20:35]
    v_mfma_f32_32x32x16_bf16 v[36:51], v[172:175], v[184:187], v[36:51]
    v_mfma_f32_32x32x16_bf16 v[52:67], v[176:179], v[180:183], v[52:67]
    v_mfma_f32_32x32x16_bf16 v[68:83], v[176:179], v[184:187], v[68:83]
    v_mfma_f32_32x32x16_bf16 v[84:99], v[172:175], v[188:191], v[84:99]
    v_mfma_f32_32x32x16_bf16 v[100:115], v[172:175], v[192:195], v[100:115]
    v_mfma_f32_32x32x16_bf16 v[116:131], v[176:179], v[188:191], v[116:131]
    v_mfma_f32_32x32x16_bf16 v[132:147], v[176:179], v[192:195], v[132:147]
    ds_read_b128 v[172:175], v14 offset:0
    ds_read_b128 v[176:179], v14 offset:4096
    ds_read_b64_tr_b16 v[180:181], v15 offset:12288
    ds_read_b64_tr_b16 v[182:183], v15 offset:13312
    ds_read_b64_tr_b16 v[184:185], v16 offset:12288
    ds_read_b64_tr_b16 v[186:187], v16 offset:13312
    ds_read_b64_tr_b16 v[188:189], v17 offset:12288
    ds_read_b64_tr_b16 v[190:191], v17 offset:13312
    ds_read_b64_tr_b16 v[192:193], v18 offset:12288
    ds_read_b64_tr_b16 v[194:195], v18 offset:13312
    s_waitcnt lgkmcnt(10)
    v_mfma_f32_32x32x16_bf16 v[20:35], v[148:151], v[156:159], v[20:35]
    v_mfma_f32_32x32x16_bf16 v[36:51], v[148:151], v[160:163], v[36:51]
    v_mfma_f32_32x32x16_bf16 v[52:67], v[152:155], v[156:159], v[52:67]
    v_mfma_f32_32x32x16_bf16 v[68:83], v[152:155], v[160:163], v[68:83]
    v_mfma_f32_32x32x16_bf16 v[84:99], v[148:151], v[164:167], v[84:99]
    v_mfma_f32_32x32x16_bf16 v[100:115], v[148:151], v[168:171], v[100:115]
    v_mfma_f32_32x32x16_bf16 v[116:131], v[152:155], v[164:167], v[116:131]
    v_mfma_f32_32x32x16_bf16 v[132:147], v[152:155], v[168:171], v[132:147]
    s_waitcnt lgkmcnt(0)
    v_mfma_f32_32x32x16_bf16 v[20:35], v[172:175], v[180:183], v[20:35]
    v_mfma_f32_32x32x16_bf16 v[36:51], v[172:175], v[184:187], v[36:51]
    v_mfma_f32_32x32x16_bf16 v[52:67], v[176:179], v[180:183], v[52:67]
    v_mfma_f32_32x32x16_bf16 v[68:83], v[176:179], v[184:187], v[68:83]
    v_mfma_f32_32x32x16_bf16 v[84:99], v[172:175], v[188:191], v[84:99]
    v_mfma_f32_32x32x16_bf16 v[100:115], v[172:175], v[192:195], v[100:115]
    v_mfma_f32_32x32x16_bf16 v[116:131], v[176:179], v[188:191], v[116:131]
    v_mfma_f32_32x32x16_bf16 v[132:147], v[176:179], v[192:195], v[132:147]
    v_subrev_u32 v11, 65536, v11
    v_subrev_u32 v12, 65536, v12
    v_subrev_u32 v13, 65536, v13
    v_subrev_u32 v14, 65536, v14
    v_subrev_u32 v15, 65536, v15
    v_subrev_u32 v16, 65536, v16
    v_subrev_u32 v17, 65536, v17
    v_subrev_u32 v18, 65536, v18
    s_sub_u32 s92, s92, 1
    s_cmp_lg_u32 s92, 0
    s_cbranch_scc1 L_k_2
    s_waitcnt vmcnt(0)
    s_barrier
    ds_read_b128 v[148:151], v11 offset:0
    ds_read_b128 v[152:155], v11 offset:4096
    ds_read_b64_tr_b16 v[156:157], v15 offset:0
    ds_read_b64_tr_b16 v[158:159], v15 offset:1024
    ds_read_b64_tr_b16 v[160:161], v16 offset:0
    ds_read_b64_tr_b16 v[162:163], v16 offset:1024
    ds_read_b64_tr_b16 v[164:165], v17 offset:0
    ds_read_b64_tr_b16 v[166:167], v17 offset:1024
    ds_read_b64_tr_b16 v[168:169], v18 offset:0
    ds_read_b64_tr_b16 v[170:171], v18 offset:1024
    s_add_u32 m0, s4, 65536
    s_nop 0
    buffer_load_dwordx4 v8, s[8:11], s24 offen lds
    s_add_u32 m0, s4, 73728
    s_add_u32 s91, s24, 131072
    buffer_load_dwordx4 v8, s[8:11], s91 offen lds
    s_add_u32 m0, s4, 81920
    s_add_u32 s91, s24, 262144
    buffer_load_dwordx4 v8, s[8:11], s91 offen lds
    s_add_u32 m0, s4, 90112
    s_add_u32 s91, s24, 393216
    buffer_load_dwordx4 v8, s[8:11], s91 offen lds
    s_add_u32 m0, s4, 98304
    s_nop 0
    buffer_load_dwordx4 v9, s[12:15], s25 offen lds
    s_add_u32 m0, s4, 106496
    s_add_u32 s91, s25, 229376
    buffer_load_dwordx4 v9, s[12:15], s91 offen lds
    s_add_u32 m0, s4, 114688
    s_nop 0
    buffer_load_dwordx4 v10, s[16:19], s26 offen lds
    s_add_u32 m0, s4, 122880
    s_add_u32 s91, s26, 229376
    buffer_load_dwordx4 v10, s[16:19], s91 offen lds
    s_add_u32 s24, s24, 128
    s_add_u32 s25, s25, 458752
    s_add_u32 s26, s26, 458752
    ds_read_b128 v[172:175], v12 offset:0
    ds_read_b128 v[176:179], v12 offset:4096
    ds_read_b64_tr_b16 v[180:181], v15 offset:4096
    ds_read_b64_tr_b16 v[182:183], v15 offset:5120
    ds_read_b64_tr_b16 v[184:185], v16 offset:4096
    ds_read_b64_tr_b16 v[186:187], v16 offset:5120
    ds_read_b64_tr_b16 v[188:189], v17 offset:4096
    ds_read_b64_tr_b16 v[190:191], v17 offset:5120
    ds_read_b64_tr_b16 v[192:193], v18 offset:4096
    ds_read_b64_tr_b16 v[194:195], v18 offset:5120
    s_waitcnt lgkmcnt(10)
    v_mfma_f32_32x32x16_bf16 v[20:35], v[148:151], v[156:159], v[20:35]
    v_mfma_f32_32x32x16_bf16 v[36:51], v[148:151], v[160:163], v[36:51]
    v_mfma_f32_32x32x16_bf16 v[52:67], v[152:155], v[156:159], v[52:67]
    v_mfma_f32_32x32x16_bf16 v[68:83], v[152:155], v[160:163], v[68:83]
    v_mfma_f32_32x32x16_bf16 v[84:99], v[148:151], v[164:167], v[84:99]
    v_mfma_f32_32x32x16_bf16 v[100:115], v[148:151], v[168:171], v[100:115]
    v_mfma_f32_32x32x16_bf16 v[116:131], v[152:155], v[164:167], v[116:131]
    v_mfma_f32_32x32x16_bf16 v[132:147], v[152:155], v[168:171], v[132:147]
    ds_read_b128 v[148:151], v13 offset:0
    ds_read_b128 v[152:155], v13 offset:4096
    ds_read_b64_tr_b16 v[156:157], v15 offset:8192
    ds_read_b64_tr_b16 v[158:159], v15 offset:9216
    ds_read_b64_tr_b16 v[160:161], v16 offset:8192
    ds_read_b64_tr_b16 v[162:163], v16 offset:9216
    ds_read_b64_tr_b16 v[164:165], v17 offset:8192
    ds_read_b64_tr_b16 v[166:167], v17 offset:9216
    ds_read_b64_tr_b16 v[168:169], v18 offset:8192
    ds_read_b64_tr_b16 v[170:171], v18 offset:9216
    s_waitcnt lgkmcnt(10)
    v_mfma_f32_32x32x16_bf16 v[20:35], v[172:175], v[180:183], v[20:35]
    v_mfma_f32_32x32x16_bf16 v[36:51], v[172:175], v[184:187], v[36:51]
    v_mfma_f32_32x32x16_bf16 v[52:67], v[176:179], v[180:183], v[52:67]
    v_mfma_f32_32x32x16_bf16 v[68:83], v[176:179], v[184:187], v[68:83]
    v_mfma_f32_32x32x16_bf16 v[84:99], v[172:175], v[188:191], v[84:99]
    v_mfma_f32_32x32x16_bf16 v[100:115], v[172:175], v[192:195], v[100:115]
    v_mfma_f32_32x32x16_bf16 v[116:131], v[176:179], v[188:191], v[116:131]
    v_mfma_f32_32x32x16_bf16 v[132:147], v[176:179], v[192:195], v[132:147]
    ds_read_b128 v[172:175], v14 offset:0
    ds_read_b128 v[176:179], v14 offset:4096
    ds_read_b64_tr_b16 v[180:181], v15 offset:12288
    ds_read_b64_tr_b16 v[182:183], v15 offset:13312
    ds_read_b64_tr_b16 v[184:185], v16 offset:12288
    ds_read_b64_tr_b16 v[186:187], v16 offset:13312
    ds_read_b64_tr_b16 v[188:189], v17 offset:12288
    ds_read_b64_tr_b16 v[190:191], v17 offset:13312
    ds_read_b64_tr_b16 v[192:193], v18 offset:12288
    ds_read_b64_tr_b16 v[194:195], v18 offset:13312
    s_waitcnt lgkmcnt(10)
    v_mfma_f32_32x32x16_bf16 v[20:35], v[148:151], v[156:159], v[20:35]
    v_mfma_f32_32x32x16_bf16 v[36:51], v[148:151], v[160:163], v[36:51]
    v_mfma_f32_32x32x16_bf16 v[52:67], v[152:155], v[156:159], v[52:67]
    v_mfma_f32_32x32x16_bf16 v[68:83], v[152:155], v[160:163], v[68:83]
    v_mfma_f32_32x32x16_bf16 v[84:99], v[148:151], v[164:167], v[84:99]
    v_mfma_f32_32x32x16_bf16 v[100:115], v[148:151], v[168:171], v[100:115]
    v_mfma_f32_32x32x16_bf16 v[116:131], v[152:155], v[164:167], v[116:131]
    v_mfma_f32_32x32x16_bf16 v[132:147], v[152:155], v[168:171], v[132:147]
    s_waitcnt lgkmcnt(0)
    v_mfma_f32_32x32x16_bf16 v[20:35], v[172:175], v[180:183], v[20:35]
    v_mfma_f32_32x32x16_bf16 v[36:51], v[172:175], v[184:187], v[36:51]
    v_mfma_f32_32x32x16_bf16 v[52:67], v[176:179], v[180:183], v[52:67]
    v_mfma_f32_32x32x16_bf16 v[68:83], v[176:179], v[184:187], v[68:83]
    v_mfma_f32_32x32x16_bf16 v[84:99], v[172:175], v[188:191], v[84:99]
    v_mfma_f32_32x32x16_bf16 v[100:115], v[172:175], v[192:195], v[100:115]
    v_mfma_f32_32x32x16_bf16 v[116:131], v[176:179], v[188:191], v[116:131]
    v_mfma_f32_32x32x16_bf16 v[132:147], v[176:179], v[192:195], v[132:147]
    s_waitcnt vmcnt(0)
    s_barrier
    v_add_u32 v11, 65536, v11
    v_add_u32 v12, 65536, v12
    v_add_u32 v13, 65536, v13
    v_add_u32 v14, 65536, v14
    v_add_u32 v15, 65536, v15
    v_add_u32 v16, 65536, v16
    v_add_u32 v17, 65536, v17
    v_add_u32 v18, 65536, v18
    ds_read_b128 v[148:151], v11 offset:0
    ds_read_b128 v[152:155], v11 offset:4096
    ds_read_b64_tr_b16 v[156:157], v15 offset:0
    ds_read_b64_tr_b16 v[158:159], v15 offset:1024
    ds_read_b64_tr_b16 v[160:161], v16 offset:0
    ds_read_b64_tr_b16 v[162:163], v16 offset:1024
    ds_read_b64_tr_b16 v[164:165], v17 offset:0
    ds_read_b64_tr_b16 v[166:167], v17 offset:1024
    ds_read_b64_tr_b16 v[168:169], v18 offset:0
    ds_read_b64_tr_b16 v[170:171], v18 offset:1024
    ds_read_b128 v[172:175], v12 offset:0
    ds_read_b128 v[176:179], v12 offset:4096
    ds_read_b64_tr_b16 v[180:181], v15 offset:4096
    ds_read_b64_tr_b16 v[182:183], v15 offset:5120
    ds_read_b64_tr_b16 v[184:185], v16 offset:4096
    ds_read_b64_tr_b16 v[186:187], v16 offset:5120
    ds_read_b64_tr_b16 v[188:189], v17 offset:4096
    ds_read_b64_tr_b16 v[190:191], v17 offset:5120
    ds_read_b64_tr_b16 v[192:193], v18 offset:4096
    ds_read_b64_tr_b16 v[194:195], v18 offset:5120
    s_waitcnt lgkmcnt(10)
    v_mfma_f32_32x32x16_bf16 v[20:35], v[148:151], v[156:159], v[20:35]
    v_mfma_f32_32x32x16_bf16 v[36:51], v[148:151], v[160:163], v[36:51]
    v_mfma_f32_32x32x16_bf16 v[52:67], v[152:155], v[156:159], v[52:67]
    v_mfma_f32_32x32x16_bf16 v[68:83], v[152:155], v[160:163], v[68:83]
    v_mfma_f32_32x32x16_bf16 v[84:99], v[148:151], v[164:167], v[84:99]
    v_mfma_f32_32x32x16_bf16 v[100:115], v[148:151], v[168:171], v[100:115]
    v_mfma_f32_32x32x16_bf16 v[116:131], v[152:155], v[164:167], v[116:131]
    v_mfma_f32_32x32x16_bf16 v[132:147], v[152:155], v[168:171], v[132:147]
    ds_read_b128 v[148:151], v13 offset:0
    ds_read_b128 v[152:155], v13 offset:4096
    ds_read_b64_tr_b16 v[156:157], v15 offset:8192
    ds_read_b64_tr_b16 v[158:159], v15 offset:9216
    ds_read_b64_tr_b16 v[160:161], v16 offset:8192
    ds_read_b64_tr_b16 v[162:163], v16 offset:9216
    ds_read_b64_tr_b16 v[164:165], v17 offset:8192
    ds_read_b64_tr_b16 v[166:167], v17 offset:9216
    ds_read_b64_tr_b16 v[168:169], v18 offset:8192
    ds_read_b64_tr_b16 v[170:171], v18 offset:9216
    s_waitcnt lgkmcnt(10)
    v_mfma_f32_32x32x16_bf16 v[20:35], v[172:175], v[180:183], v[20:35]
    v_mfma_f32_32x32x16_bf16 v[36:51], v[172:175], v[184:187], v[36:51]
    v_mfma_f32_32x32x16_bf16 v[52:67], v[176:179], v[180:183], v[52:67]
    v_mfma_f32_32x32x16_bf16 v[68:83], v[176:179], v[184:187], v[68:83]
    v_mfma_f32_32x32x16_bf16 v[84:99], v[172:175], v[188:191], v[84:99]
    v_mfma_f32_32x32x16_bf16 v[100:115], v[172:175], v[192:195], v[100:115]
    v_mfma_f32_32x32x16_bf16 v[116:131], v[176:179], v[188:191], v[116:131]
    v_mfma_f32_32x32x16_bf16 v[132:147], v[176:179], v[192:195], v[132:147]
    ds_read_b128 v[172:175], v14 offset:0
    ds_read_b128 v[176:179], v14 offset:4096
    ds_read_b64_tr_b16 v[180:181], v15 offset:12288
    ds_read_b64_tr_b16 v[182:183], v15 offset:13312
    ds_read_b64_tr_b16 v[184:185], v16 offset:12288
    ds_read_b64_tr_b16 v[186:187], v16 offset:13312
    ds_read_b64_tr_b16 v[188:189], v17 offset:12288
    ds_read_b64_tr_b16 v[190:191], v17 offset:13312
    ds_read_b64_tr_b16 v[192:193], v18 offset:12288
    ds_read_b64_tr_b16 v[194:195], v18 offset:13312
    s_waitcnt lgkmcnt(10)
    v_mfma_f32_32x32x16_bf16 v[20:35], v[148:151], v[156:159], v[20:35]
    v_mfma_f32_32x32x16_bf16 v[36:51], v[148:151], v[160:163], v[36:51]
    v_mfma_f32_32x32x16_bf16 v[52:67], v[152:155], v[156:159], v[52:67]
    v_mfma_f32_32x32x16_bf16 v[68:83], v[152:155], v[160:163], v[68:83]
    v_mfma_f32_32x32x16_bf16 v[84:99], v[148:151], v[164:167], v[84:99]
    v_mfma_f32_32x32x16_bf16 v[100:115], v[148:151], v[168:171], v[100:115]
    v_mfma_f32_32x32x16_bf16 v[116:131], v[152:155], v[164:167], v[116:131]
    v_mfma_f32_32x32x16_bf16 v[132:147], v[152:155], v[168:171], v[132:147]
    s_waitcnt lgkmcnt(0)
    v_mfma_f32_32x32x16_bf16 v[20:35], v[172:175], v[180:183], v[20:35]
    v_mfma_f32_32x32x16_bf16 v[36:51], v[172:175], v[184:187], v[36:51]
    v_mfma_f32_32x32x16_bf16 v[52:67], v[176:179], v[180:183], v[52:67]
    v_mfma_f32_32x32x16_bf16 v[68:83], v[176:179], v[184:187], v[68:83]
    v_mfma_f32_32x32x16_bf16 v[84:99], v[172:175], v[188:191], v[84:99]
    v_mfma_f32_32x32x16_bf16 v[100:115], v[172:175], v[192:195], v[100:115]
    v_mfma_f32_32x32x16_bf16 v[116:131], v[176:179], v[188:191], v[116:131]
    v_mfma_f32_32x32x16_bf16 v[132:147], v[176:179], v[192:195], v[132:147]
    v_subrev_u32 v11, 65536, v11
    v_subrev_u32 v12, 65536, v12
    v_subrev_u32 v13, 65536, v13
    v_subrev_u32 v14, 65536, v14
    v_subrev_u32 v15, 65536, v15
    v_subrev_u32 v16, 65536, v16
    v_subrev_u32 v17, 65536, v17
    v_subrev_u32 v18, 65536, v18
    s_nop 15
    s_barrier
    v_lshrrev_b32 v196, 5, v1
    v_lshlrev_b32 v196, 2, v196
    v_add_u32 v196, s32, v196
    v_lshlrev_b32 v196, 8, v196
    v_and_b32 v197, 31, v1
    v_add_u32 v197, s33, v197
    v_lshl_add_u32 v196, v197, 1, v196
    v_cvt_pk_bf16_f32 v197, v20, v84
    v_and_b32 v198, 0xffff0000, v197
    v_lshlrev_b32 v197, 16, v197
    v_mul_f32 v199, v197, v197
    v_mov_b32 v200, 1.0
    v_fmac_f32 v200, 0x3d372713, v199
    v_mul_f32 v200, v200, v197
    v_mul_f32 v200, 0xc0135761, v200
    v_exp_f32 v200, v200
    s_nop 0
    v_add_f32 v200, 1.0, v200
    v_rcp_f32 v200, v200
    s_nop 0
    v_mul_f32 v200, v200, v197
    v_cvt_pk_bf16_f32 v200, v200, v200
    v_lshlrev_b32 v200, 16, v200
    v_mul_f32 v200, v200, v198
    v_cvt_pk_bf16_f32 v200, v200, v200
    ds_write_b16 v196, v200 offset:0
    v_cvt_pk_bf16_f32 v197, v21, v85
    v_and_b32 v198, 0xffff0000, v197
    v_lshlrev_b32 v197, 16, v197
    v_mul_f32 v199, v197, v197
    v_mov_b32 v200, 1.0
    v_fmac_f32 v200, 0x3d372713, v199
    v_mul_f32 v200, v200, v197
    v_mul_f32 v200, 0xc0135761, v200
    v_exp_f32 v200, v200
    s_nop 0
    v_add_f32 v200, 1.0, v200
    v_rcp_f32 v200, v200
    s_nop 0
    v_mul_f32 v200, v200, v197
    v_cvt_pk_bf16_f32 v200, v200, v200
    v_lshlrev_b32 v200, 16, v200
    v_mul_f32 v200, v200, v198
    v_cvt_pk_bf16_f32 v200, v200, v200
    ds_write_b16 v196, v200 offset:256
    v_cvt_pk_bf16_f32 v197, v22, v86
    v_and_b32 v198, 0xffff0000, v197
    v_lshlrev_b32 v197, 16, v197
    v_mul_f32 v199, v197, v197
    v_mov_b32 v200, 1.0
    v_fmac_f32 v200, 0x3d372713, v199
    v_mul_f32 v200, v200, v197
    v_mul_f32 v200, 0xc0135761, v200
    v_exp_f32 v200, v200
    s_nop 0
    v_add_f32 v200, 1.0, v200
    v_rcp_f32 v200, v200
    s_nop 0
    v_mul_f32 v200, v200, v197
    v_cvt_pk_bf16_f32 v200, v200, v200
    v_lshlrev_b32 v200, 16, v200
    v_mul_f32 v200, v200, v198
    v_cvt_pk_bf16_f32 v200, v200, v200
    ds_write_b16 v196, v200 offset:512
    v_cvt_pk_bf16_f32 v197, v23, v87
    v_and_b32 v198, 0xffff0000, v197
    v_lshlrev_b32 v197, 16, v197
    v_mul_f32 v199, v197, v197
    v_mov_b32 v200, 1.0
    v_fmac_f32 v200, 0x3d372713, v199
    v_mul_f32 v200, v200, v197
    v_mul_f32 v200, 0xc0135761, v200
    v_exp_f32 v200, v200
    s_nop 0
    v_add_f32 v200, 1.0, v200
    v_rcp_f32 v200, v200
    s_nop 0
    v_mul_f32 v200, v200, v197
    v_cvt_pk_bf16_f32 v200, v200, v200
    v_lshlrev_b32 v200, 16, v200
    v_mul_f32 v200, v200, v198
    v_cvt_pk_bf16_f32 v200, v200, v200
    ds_write_b16 v196, v200 offset:768
    v_cvt_pk_bf16_f32 v197, v24, v88
    v_and_b32 v198, 0xffff0000, v197
    v_lshlrev_b32 v197, 16, v197
    v_mul_f32 v199, v197, v197
    v_mov_b32 v200, 1.0
    v_fmac_f32 v200, 0x3d372713, v199
    v_mul_f32 v200, v200, v197
    v_mul_f32 v200, 0xc0135761, v200
    v_exp_f32 v200, v200
    s_nop 0
    v_add_f32 v200, 1.0, v200
    v_rcp_f32 v200, v200
    s_nop 0
    v_mul_f32 v200, v200, v197
    v_cvt_pk_bf16_f32 v200, v200, v200
    v_lshlrev_b32 v200, 16, v200
    v_mul_f32 v200, v200, v198
    v_cvt_pk_bf16_f32 v200, v200, v200
    ds_write_b16 v196, v200 offset:2048
    v_cvt_pk_bf16_f32 v197, v25, v89
    v_and_b32 v198, 0xffff0000, v197
    v_lshlrev_b32 v197, 16, v197
    v_mul_f32 v199, v197, v197
    v_mov_b32 v200, 1.0
    v_fmac_f32 v200, 0x3d372713, v199
    v_mul_f32 v200, v200, v197
    v_mul_f32 v200, 0xc0135761, v200
    v_exp_f32 v200, v200
    s_nop 0
    v_add_f32 v200, 1.0, v200
    v_rcp_f32 v200, v200
    s_nop 0
    v_mul_f32 v200, v200, v197
    v_cvt_pk_bf16_f32 v200, v200, v200
    v_lshlrev_b32 v200, 16, v200
    v_mul_f32 v200, v200, v198
    v_cvt_pk_bf16_f32 v200, v200, v200
    ds_write_b16 v196, v200 offset:2304
    v_cvt_pk_bf16_f32 v197, v26, v90
    v_and_b32 v198, 0xffff0000, v197
    v_lshlrev_b32 v197, 16, v197
    v_mul_f32 v199, v197, v197
    v_mov_b32 v200, 1.0
    v_fmac_f32 v200, 0x3d372713, v199
    v_mul_f32 v200, v200, v197
    v_mul_f32 v200, 0xc0135761, v200
    v_exp_f32 v200, v200
    s_nop 0
    v_add_f32 v200, 1.0, v200
    v_rcp_f32 v200, v200
    s_nop 0
    v_mul_f32 v200, v200, v197
    v_cvt_pk_bf16_f32 v200, v200, v200
    v_lshlrev_b32 v200, 16, v200
    v_mul_f32 v200, v200, v198
    v_cvt_pk_bf16_f32 v200, v200, v200
    ds_write_b16 v196, v200 offset:2560
    v_cvt_pk_bf16_f32 v197, v27, v91
    v_and_b32 v198, 0xffff0000, v197
    v_lshlrev_b32 v197, 16, v197
    v_mul_f32 v199, v197, v197
    v_mov_b32 v200, 1.0
    v_fmac_f32 v200, 0x3d372713, v199
    v_mul_f32 v200, v200, v197
    v_mul_f32 v200, 0xc0135761, v200
    v_exp_f32 v200, v200
    s_nop 0
    v_add_f32 v200, 1.0, v200
    v_rcp_f32 v200, v200
    s_nop 0
    v_mul_f32 v200, v200, v197
    v_cvt_pk_bf16_f32 v200, v200, v200
    v_lshlrev_b32 v200, 16, v200
    v_mul_f32 v200, v200, v198
    v_cvt_pk_bf16_f32 v200, v200, v200
    ds_write_b16 v196, v200 offset:2816
    v_cvt_pk_bf16_f32 v197, v28, v92
    v_and_b32 v198, 0xffff0000, v197
    v_lshlrev_b32 v197, 16, v197
    v_mul_f32 v199, v197, v197
    v_mov_b32 v200, 1.0
    v_fmac_f32 v200, 0x3d372713, v199
    v_mul_f32 v200, v200, v197
    v_mul_f32 v200, 0xc0135761, v200
    v_exp_f32 v200, v200
    s_nop 0
    v_add_f32 v200, 1.0, v200
    v_rcp_f32 v200, v200
    s_nop 0
    v_mul_f32 v200, v200, v197
    v_cvt_pk_bf16_f32 v200, v200, v200
    v_lshlrev_b32 v200, 16, v200
    v_mul_f32 v200, v200, v198
    v_cvt_pk_bf16_f32 v200, v200, v200
    ds_write_b16 v196, v200 offset:4096
    v_cvt_pk_bf16_f32 v197, v29, v93
    v_and_b32 v198, 0xffff0000, v197
    v_lshlrev_b32 v197, 16, v197
    v_mul_f32 v199, v197, v197
    v_mov_b32 v200, 1.0
    v_fmac_f32 v200, 0x3d372713, v199
    v_mul_f32 v200, v200, v197
    v_mul_f32 v200, 0xc0135761, v200
    v_exp_f32 v200, v200
    s_nop 0
    v_add_f32 v200, 1.0, v200
    v_rcp_f32 v200, v200
    s_nop 0
    v_mul_f32 v200, v200, v197
    v_cvt_pk_bf16_f32 v200, v200, v200
    v_lshlrev_b32 v200, 16, v200
    v_mul_f32 v200, v200, v198
    v_cvt_pk_bf16_f32 v200, v200, v200
    ds_write_b16 v196, v200 offset:4352
    v_cvt_pk_bf16_f32 v197, v30, v94
    v_and_b32 v198, 0xffff0000, v197
    v_lshlrev_b32 v197, 16, v197
    v_mul_f32 v199, v197, v197
    v_mov_b32 v200, 1.0
    v_fmac_f32 v200, 0x3d372713, v199
    v_mul_f32 v200, v200, v197
    v_mul_f32 v200, 0xc0135761, v200
    v_exp_f32 v200, v200
    s_nop 0
    v_add_f32 v200, 1.0, v200
    v_rcp_f32 v200, v200
    s_nop 0
    v_mul_f32 v200, v200, v197
    v_cvt_pk_bf16_f32 v200, v200, v200
    v_lshlrev_b32 v200, 16, v200
    v_mul_f32 v200, v200, v198
    v_cvt_pk_bf16_f32 v200, v200, v200
    ds_write_b16 v196, v200 offset:4608
    v_cvt_pk_bf16_f32 v197, v31, v95
    v_and_b32 v198, 0xffff0000, v197
    v_lshlrev_b32 v197, 16, v197
    v_mul_f32 v199, v197, v197
    v_mov_b32 v200, 1.0
    v_fmac_f32 v200, 0x3d372713, v199
    v_mul_f32 v200, v200, v197
    v_mul_f32 v200, 0xc0135761, v200
    v_exp_f32 v200, v200
    s_nop 0
    v_add_f32 v200, 1.0, v200
    v_rcp_f32 v200, v200
    s_nop 0
    v_mul_f32 v200, v200, v197
    v_cvt_pk_bf16_f32 v200, v200, v200
    v_lshlrev_b32 v200, 16, v200
    v_mul_f32 v200, v200, v198
    v_cvt_pk_bf16_f32 v200, v200, v200
    ds_write_b16 v196, v200 offset:4864
    v_cvt_pk_bf16_f32 v197, v32, v96
    v_and_b32 v198, 0xffff0000, v197
    v_lshlrev_b32 v197, 16, v197
    v_mul_f32 v199, v197, v197
    v_mov_b32 v200, 1.0
    v_fmac_f32 v200, 0x3d372713, v199
    v_mul_f32 v200, v200, v197
    v_mul_f32 v200, 0xc0135761, v200
    v_exp_f32 v200, v200
    s_nop 0
    v_add_f32 v200, 1.0, v200
    v_rcp_f32 v200, v200
    s_nop 0
    v_mul_f32 v200, v200, v197
    v_cvt_pk_bf16_f32 v200, v200, v200
    v_lshlrev_b32 v200, 16, v200
    v_mul_f32 v200, v200, v198
    v_cvt_pk_bf16_f32 v200, v200, v200
    ds_write_b16 v196, v200 offset:6144
    v_cvt_pk_bf16_f32 v197, v33, v97
    v_and_b32 v198, 0xffff0000, v197
    v_lshlrev_b32 v197, 16, v197
    v_mul_f32 v199, v197, v197
    v_mov_b32 v200, 1.0
    v_fmac_f32 v200, 0x3d372713, v199
    v_mul_f32 v200, v200, v197
    v_mul_f32 v200, 0xc0135761, v200
    v_exp_f32 v200, v200
    s_nop 0
    v_add_f32 v200, 1.0, v200
    v_rcp_f32 v200, v200
    s_nop 0
    v_mul_f32 v200, v200, v197
    v_cvt_pk_bf16_f32 v200, v200, v200
    v_lshlrev_b32 v200, 16, v200
    v_mul_f32 v200, v200, v198
    v_cvt_pk_bf16_f32 v200, v200, v200
    ds_write_b16 v196, v200 offset:6400
    v_cvt_pk_bf16_f32 v197, v34, v98
    v_and_b32 v198, 0xffff0000, v197
    v_lshlrev_b32 v197, 16, v197
    v_mul_f32 v199, v197, v197
    v_mov_b32 v200, 1.0
    v_fmac_f32 v200, 0x3d372713, v199
    v_mul_f32 v200, v200, v197
    v_mul_f32 v200, 0xc0135761, v200
    v_exp_f32 v200, v200
    s_nop 0
    v_add_f32 v200, 1.0, v200
    v_rcp_f32 v200, v200
    s_nop 0
    v_mul_f32 v200, v200, v197
    v_cvt_pk_bf16_f32 v200, v200, v200
    v_lshlrev_b32 v200, 16, v200
    v_mul_f32 v200, v200, v198
    v_cvt_pk_bf16_f32 v200, v200, v200
    ds_write_b16 v196, v200 offset:6656
    v_cvt_pk_bf16_f32 v197, v35, v99
    v_and_b32 v198, 0xffff0000, v197
    v_lshlrev_b32 v197, 16, v197
    v_mul_f32 v199, v197, v197
    v_mov_b32 v200, 1.0
    v_fmac_f32 v200, 0x3d372713, v199
    v_mul_f32 v200, v200, v197
    v_mul_f32 v200, 0xc0135761, v200
    v_exp_f32 v200, v200
    s_nop 0
    v_add_f32 v200, 1.0, v200
    v_rcp_f32 v200, v200
    s_nop 0
    v_mul_f32 v200, v200, v197
    v_cvt_pk_bf16_f32 v200, v200, v200
    v_lshlrev_b32 v200, 16, v200
    v_mul_f32 v200, v200, v198
    v_cvt_pk_bf16_f32 v200, v200, v200
    ds_write_b16 v196, v200 offset:6912
    v_cvt_pk_bf16_f32 v197, v36, v100
    v_and_b32 v198, 0xffff0000, v197
    v_lshlrev_b32 v197, 16, v197
    v_mul_f32 v199, v197, v197
    v_mov_b32 v200, 1.0
    v_fmac_f32 v200, 0x3d372713, v199
    v_mul_f32 v200, v200, v197
    v_mul_f32 v200, 0xc0135761, v200
    v_exp_f32 v200, v200
    s_nop 0
    v_add_f32 v200, 1.0, v200
    v_rcp_f32 v200, v200
    s_nop 0
    v_mul_f32 v200, v200, v197
    v_cvt_pk_bf16_f32 v200, v200, v200
    v_lshlrev_b32 v200, 16, v200
    v_mul_f32 v200, v200, v198
    v_cvt_pk_bf16_f32 v200, v200, v200
    ds_write_b16 v196, v200 offset:64
    v_cvt_pk_bf16_f32 v197, v37, v101
    v_and_b32 v198, 0xffff0000, v197
    v_lshlrev_b32 v197, 16, v197
    v_mul_f32 v199, v197, v197
    v_mov_b32 v200, 1.0
    v_fmac_f32 v200, 0x3d372713, v199
    v_mul_f32 v200, v200, v197
    v_mul_f32 v200, 0xc0135761, v200
    v_exp_f32 v200, v200
    s_nop 0
    v_add_f32 v200, 1.0, v200
    v_rcp_f32 v200, v200
    s_nop 0
    v_mul_f32 v200, v200, v197
    v_cvt_pk_bf16_f32 v200, v200, v200
    v_lshlrev_b32 v200, 16, v200
    v_mul_f32 v200, v200, v198
    v_cvt_pk_bf16_f32 v200, v200, v200
    ds_write_b16 v196, v200 offset:320
    v_cvt_pk_bf16_f32 v197, v38, v102
    v_and_b32 v198, 0xffff0000, v197
    v_lshlrev_b32 v197, 16, v197
    v_mul_f32 v199, v197, v197
    v_mov_b32 v200, 1.0
    v_fmac_f32 v200, 0x3d372713, v199
    v_mul_f32 v200, v200, v197
    v_mul_f32 v200, 0xc0135761, v200
    v_exp_f32 v200, v200
    s_nop 0
    v_add_f32 v200, 1.0, v200
    v_rcp_f32 v200, v200
    s_nop 0
    v_mul_f32 v200, v200, v197
    v_cvt_pk_bf16_f32 v200, v200, v200
    v_lshlrev_b32 v200, 16, v200
    v_mul_f32 v200, v200, v198
    v_cvt_pk_bf16_f32 v200, v200, v200
    ds_write_b16 v196, v200 offset:576
    v_cvt_pk_bf16_f32 v197, v39, v103
    v_and_b32 v198, 0xffff0000, v197
    v_lshlrev_b32 v197, 16, v197
    v_mul_f32 v199, v197, v197
    v_mov_b32 v200, 1.0
    v_fmac_f32 v200, 0x3d372713, v199
    v_mul_f32 v200, v200, v197
    v_mul_f32 v200, 0xc0135761, v200
    v_exp_f32 v200, v200
    s_nop 0
    v_add_f32 v200, 1.0, v200
    v_rcp_f32 v200, v200
    s_nop 0
    v_mul_f32 v200, v200, v197
    v_cvt_pk_bf16_f32 v200, v200, v200
    v_lshlrev_b32 v200, 16, v200
    v_mul_f32 v200, v200, v198
    v_cvt_pk_bf16_f32 v200, v200, v200
    ds_write_b16 v196, v200 offset:832
    v_cvt_pk_bf16_f32 v197, v40, v104
    v_and_b32 v198, 0xffff0000, v197
    v_lshlrev_b32 v197, 16, v197
    v_mul_f32 v199, v197, v197
    v_mov_b32 v200, 1.0
    v_fmac_f32 v200, 0x3d372713, v199
    v_mul_f32 v200, v200, v197
    v_mul_f32 v200, 0xc0135761, v200
    v_exp_f32 v200, v200
    s_nop 0
    v_add_f32 v200, 1.0, v200
    v_rcp_f32 v200, v200
    s_nop 0
    v_mul_f32 v200, v200, v197
    v_cvt_pk_bf16_f32 v200, v200, v200
    v_lshlrev_b32 v200, 16, v200
    v_mul_f32 v200, v200, v198
    v_cvt_pk_bf16_f32 v200, v200, v200
    ds_write_b16 v196, v200 offset:2112
    v_cvt_pk_bf16_f32 v197, v41, v105
    v_and_b32 v198, 0xffff0000, v197
    v_lshlrev_b32 v197, 16, v197
    v_mul_f32 v199, v197, v197
    v_mov_b32 v200, 1.0
    v_fmac_f32 v200, 0x3d372713, v199
    v_mul_f32 v200, v200, v197
    v_mul_f32 v200, 0xc0135761, v200
    v_exp_f32 v200, v200
    s_nop 0
    v_add_f32 v200, 1.0, v200
    v_rcp_f32 v200, v200
    s_nop 0
    v_mul_f32 v200, v200, v197
    v_cvt_pk_bf16_f32 v200, v200, v200
    v_lshlrev_b32 v200, 16, v200
    v_mul_f32 v200, v200, v198
    v_cvt_pk_bf16_f32 v200, v200, v200
    ds_write_b16 v196, v200 offset:2368
    v_cvt_pk_bf16_f32 v197, v42, v106
    v_and_b32 v198, 0xffff0000, v197
    v_lshlrev_b32 v197, 16, v197
    v_mul_f32 v199, v197, v197
    v_mov_b32 v200, 1.0
    v_fmac_f32 v200, 0x3d372713, v199
    v_mul_f32 v200, v200, v197
    v_mul_f32 v200, 0xc0135761, v200
    v_exp_f32 v200, v200
    s_nop 0
    v_add_f32 v200, 1.0, v200
    v_rcp_f32 v200, v200
    s_nop 0
    v_mul_f32 v200, v200, v197
    v_cvt_pk_bf16_f32 v200, v200, v200
    v_lshlrev_b32 v200, 16, v200
    v_mul_f32 v200, v200, v198
    v_cvt_pk_bf16_f32 v200, v200, v200
    ds_write_b16 v196, v200 offset:2624
    v_cvt_pk_bf16_f32 v197, v43, v107
    v_and_b32 v198, 0xffff0000, v197
    v_lshlrev_b32 v197, 16, v197
    v_mul_f32 v199, v197, v197
    v_mov_b32 v200, 1.0
    v_fmac_f32 v200, 0x3d372713, v199
    v_mul_f32 v200, v200, v197
    v_mul_f32 v200, 0xc0135761, v200
    v_exp_f32 v200, v200
    s_nop 0
    v_add_f32 v200, 1.0, v200
    v_rcp_f32 v200, v200
    s_nop 0
    v_mul_f32 v200, v200, v197
    v_cvt_pk_bf16_f32 v200, v200, v200
    v_lshlrev_b32 v200, 16, v200
    v_mul_f32 v200, v200, v198
    v_cvt_pk_bf16_f32 v200, v200, v200
    ds_write_b16 v196, v200 offset:2880
    v_cvt_pk_bf16_f32 v197, v44, v108
    v_and_b32 v198, 0xffff0000, v197
    v_lshlrev_b32 v197, 16, v197
    v_mul_f32 v199, v197, v197
    v_mov_b32 v200, 1.0
    v_fmac_f32 v200, 0x3d372713, v199
    v_mul_f32 v200, v200, v197
    v_mul_f32 v200, 0xc0135761, v200
    v_exp_f32 v200, v200
    s_nop 0
    v_add_f32 v200, 1.0, v200
    v_rcp_f32 v200, v200
    s_nop 0
    v_mul_f32 v200, v200, v197
    v_cvt_pk_bf16_f32 v200, v200, v200
    v_lshlrev_b32 v200, 16, v200
    v_mul_f32 v200, v200, v198
    v_cvt_pk_bf16_f32 v200, v200, v200
    ds_write_b16 v196, v200 offset:4160
    v_cvt_pk_bf16_f32 v197, v45, v109
    v_and_b32 v198, 0xffff0000, v197
    v_lshlrev_b32 v197, 16, v197
    v_mul_f32 v199, v197, v197
    v_mov_b32 v200, 1.0
    v_fmac_f32 v200, 0x3d372713, v199
    v_mul_f32 v200, v200, v197
    v_mul_f32 v200, 0xc0135761, v200
    v_exp_f32 v200, v200
    s_nop 0
    v_add_f32 v200, 1.0, v200
    v_rcp_f32 v200, v200
    s_nop 0
    v_mul_f32 v200, v200, v197
    v_cvt_pk_bf16_f32 v200, v200, v200
    v_lshlrev_b32 v200, 16, v200
    v_mul_f32 v200, v200, v198
    v_cvt_pk_bf16_f32 v200, v200, v200
    ds_write_b16 v196, v200 offset:4416
    v_cvt_pk_bf16_f32 v197, v46, v110
    v_and_b32 v198, 0xffff0000, v197
    v_lshlrev_b32 v197, 16, v197
    v_mul_f32 v199, v197, v197
    v_mov_b32 v200, 1.0
    v_fmac_f32 v200, 0x3d372713, v199
    v_mul_f32 v200, v200, v197
    v_mul_f32 v200, 0xc0135761, v200
    v_exp_f32 v200, v200
    s_nop 0
    v_add_f32 v200, 1.0, v200
    v_rcp_f32 v200, v200
    s_nop 0
    v_mul_f32 v200, v200, v197
    v_cvt_pk_bf16_f32 v200, v200, v200
    v_lshlrev_b32 v200, 16, v200
    v_mul_f32 v200, v200, v198
    v_cvt_pk_bf16_f32 v200, v200, v200
    ds_write_b16 v196, v200 offset:4672
    v_cvt_pk_bf16_f32 v197, v47, v111
    v_and_b32 v198, 0xffff0000, v197
    v_lshlrev_b32 v197, 16, v197
    v_mul_f32 v199, v197, v197
    v_mov_b32 v200, 1.0
    v_fmac_f32 v200, 0x3d372713, v199
    v_mul_f32 v200, v200, v197
    v_mul_f32 v200, 0xc0135761, v200
    v_exp_f32 v200, v200
    s_nop 0
    v_add_f32 v200, 1.0, v200
    v_rcp_f32 v200, v200
    s_nop 0
    v_mul_f32 v200, v200, v197
    v_cvt_pk_bf16_f32 v200, v200, v200
    v_lshlrev_b32 v200, 16, v200
    v_mul_f32 v200, v200, v198
    v_cvt_pk_bf16_f32 v200, v200, v200
    ds_write_b16 v196, v200 offset:4928
    v_cvt_pk_bf16_f32 v197, v48, v112
    v_and_b32 v198, 0xffff0000, v197
    v_lshlrev_b32 v197, 16, v197
    v_mul_f32 v199, v197, v197
    v_mov_b32 v200, 1.0
    v_fmac_f32 v200, 0x3d372713, v199
    v_mul_f32 v200, v200, v197
    v_mul_f32 v200, 0xc0135761, v200
    v_exp_f32 v200, v200
    s_nop 0
    v_add_f32 v200, 1.0, v200
    v_rcp_f32 v200, v200
    s_nop 0
    v_mul_f32 v200, v200, v197
    v_cvt_pk_bf16_f32 v200, v200, v200
    v_lshlrev_b32 v200, 16, v200
    v_mul_f32 v200, v200, v198
    v_cvt_pk_bf16_f32 v200, v200, v200
    ds_write_b16 v196, v200 offset:6208
    v_cvt_pk_bf16_f32 v197, v49, v113
    v_and_b32 v198, 0xffff0000, v197
    v_lshlrev_b32 v197, 16, v197
    v_mul_f32 v199, v197, v197
    v_mov_b32 v200, 1.0
    v_fmac_f32 v200, 0x3d372713, v199
    v_mul_f32 v200, v200, v197
    v_mul_f32 v200, 0xc0135761, v200
    v_exp_f32 v200, v200
    s_nop 0
    v_add_f32 v200, 1.0, v200
    v_rcp_f32 v200, v200
    s_nop 0
    v_mul_f32 v200, v200, v197
    v_cvt_pk_bf16_f32 v200, v200, v200
    v_lshlrev_b32 v200, 16, v200
    v_mul_f32 v200, v200, v198
    v_cvt_pk_bf16_f32 v200, v200, v200
    ds_write_b16 v196, v200 offset:6464
    v_cvt_pk_bf16_f32 v197, v50, v114
    v_and_b32 v198, 0xffff0000, v197
    v_lshlrev_b32 v197, 16, v197
    v_mul_f32 v199, v197, v197
    v_mov_b32 v200, 1.0
    v_fmac_f32 v200, 0x3d372713, v199
    v_mul_f32 v200, v200, v197
    v_mul_f32 v200, 0xc0135761, v200
    v_exp_f32 v200, v200
    s_nop 0
    v_add_f32 v200, 1.0, v200
    v_rcp_f32 v200, v200
    s_nop 0
    v_mul_f32 v200, v200, v197
    v_cvt_pk_bf16_f32 v200, v200, v200
    v_lshlrev_b32 v200, 16, v200
    v_mul_f32 v200, v200, v198
    v_cvt_pk_bf16_f32 v200, v200, v200
    ds_write_b16 v196, v200 offset:6720
    v_cvt_pk_bf16_f32 v197, v51, v115
    v_and_b32 v198, 0xffff0000, v197
    v_lshlrev_b32 v197, 16, v197
    v_mul_f32 v199, v197, v197
    v_mov_b32 v200, 1.0
    v_fmac_f32 v200, 0x3d372713, v199
    v_mul_f32 v200, v200, v197
    v_mul_f32 v200, 0xc0135761, v200
    v_exp_f32 v200, v200
    s_nop 0
    v_add_f32 v200, 1.0, v200
    v_rcp_f32 v200, v200
    s_nop 0
    v_mul_f32 v200, v200, v197
    v_cvt_pk_bf16_f32 v200, v200, v200
    v_lshlrev_b32 v200, 16, v200
    v_mul_f32 v200, v200, v198
    v_cvt_pk_bf16_f32 v200, v200, v200
    ds_write_b16 v196, v200 offset:6976
    v_cvt_pk_bf16_f32 v197, v52, v116
    v_and_b32 v198, 0xffff0000, v197
    v_lshlrev_b32 v197, 16, v197
    v_mul_f32 v199, v197, v197
    v_mov_b32 v200, 1.0
    v_fmac_f32 v200, 0x3d372713, v199
    v_mul_f32 v200, v200, v197
    v_mul_f32 v200, 0xc0135761, v200
    v_exp_f32 v200, v200
    s_nop 0
    v_add_f32 v200, 1.0, v200
    v_rcp_f32 v200, v200
    s_nop 0
    v_mul_f32 v200, v200, v197
    v_cvt_pk_bf16_f32 v200, v200, v200
    v_lshlrev_b32 v200, 16, v200
    v_mul_f32 v200, v200, v198
    v_cvt_pk_bf16_f32 v200, v200, v200
    ds_write_b16 v196, v200 offset:8192
    v_cvt_pk_bf16_f32 v197, v53, v117
    v_and_b32 v198, 0xffff0000, v197
    v_lshlrev_b32 v197, 16, v197
    v_mul_f32 v199, v197, v197
    v_mov_b32 v200, 1.0
    v_fmac_f32 v200, 0x3d372713, v199
    v_mul_f32 v200, v200, v197
    v_mul_f32 v200, 0xc0135761, v200
    v_exp_f32 v200, v200
    s_nop 0
    v_add_f32 v200, 1.0, v200
    v_rcp_f32 v200, v200
    s_nop 0
    v_mul_f32 v200, v200, v197
    v_cvt_pk_bf16_f32 v200, v200, v200
    v_lshlrev_b32 v200, 16, v200
    v_mul_f32 v200, v200, v198
    v_cvt_pk_bf16_f32 v200, v200, v200
    ds_write_b16 v196, v200 offset:8448
    v_cvt_pk_bf16_f32 v197, v54, v118
    v_and_b32 v198, 0xffff0000, v197
    v_lshlrev_b32 v197, 16, v197
    v_mul_f32 v199, v197, v197
    v_mov_b32 v200, 1.0
    v_fmac_f32 v200, 0x3d372713, v199
    v_mul_f32 v200, v200, v197
    v_mul_f32 v200, 0xc0135761, v200
    v_exp_f32 v200, v200
    s_nop 0
    v_add_f32 v200, 1.0, v200
    v_rcp_f32 v200, v200
    s_nop 0
    v_mul_f32 v200, v200, v197
    v_cvt_pk_bf16_f32 v200, v200, v200
    v_lshlrev_b32 v200, 16, v200
    v_mul_f32 v200, v200, v198
    v_cvt_pk_bf16_f32 v200, v200, v200
    ds_write_b16 v196, v200 offset:8704
    v_cvt_pk_bf16_f32 v197, v55, v119
    v_and_b32 v198, 0xffff0000, v197
    v_lshlrev_b32 v197, 16, v197
    v_mul_f32 v199, v197, v197
    v_mov_b32 v200, 1.0
    v_fmac_f32 v200, 0x3d372713, v199
    v_mul_f32 v200, v200, v197
    v_mul_f32 v200, 0xc0135761, v200
    v_exp_f32 v200, v200
    s_nop 0
    v_add_f32 v200, 1.0, v200
    v_rcp_f32 v200, v200
    s_nop 0
    v_mul_f32 v200, v200, v197
    v_cvt_pk_bf16_f32 v200, v200, v200
    v_lshlrev_b32 v200, 16, v200
    v_mul_f32 v200, v200, v198
    v_cvt_pk_bf16_f32 v200, v200, v200
    ds_write_b16 v196, v200 offset:8960
    v_cvt_pk_bf16_f32 v197, v56, v120
    v_and_b32 v198, 0xffff0000, v197
    v_lshlrev_b32 v197, 16, v197
    v_mul_f32 v199, v197, v197
    v_mov_b32 v200, 1.0
    v_fmac_f32 v200, 0x3d372713, v199
    v_mul_f32 v200, v200, v197
    v_mul_f32 v200, 0xc0135761, v200
    v_exp_f32 v200, v200
    s_nop 0
    v_add_f32 v200, 1.0, v200
    v_rcp_f32 v200, v200
    s_nop 0
    v_mul_f32 v200, v200, v197
    v_cvt_pk_bf16_f32 v200, v200, v200
    v_lshlrev_b32 v200, 16, v200
    v_mul_f32 v200, v200, v198
    v_cvt_pk_bf16_f32 v200, v200, v200
    ds_write_b16 v196, v200 offset:10240
    v_cvt_pk_bf16_f32 v197, v57, v121
    v_and_b32 v198, 0xffff0000, v197
    v_lshlrev_b32 v197, 16, v197
    v_mul_f32 v199, v197, v197
    v_mov_b32 v200, 1.0
    v_fmac_f32 v200, 0x3d372713, v199
    v_mul_f32 v200, v200, v197
    v_mul_f32 v200, 0xc0135761, v200
    v_exp_f32 v200, v200
    s_nop 0
    v_add_f32 v200, 1.0, v200
    v_rcp_f32 v200, v200
    s_nop 0
    v_mul_f32 v200, v200, v197
    v_cvt_pk_bf16_f32 v200, v200, v200
    v_lshlrev_b32 v200, 16, v200
    v_mul_f32 v200, v200, v198
    v_cvt_pk_bf16_f32 v200, v200, v200
    ds_write_b16 v196, v200 offset:10496
    v_cvt_pk_bf16_f32 v197, v58, v122
    v_and_b32 v198, 0xffff0000, v197
    v_lshlrev_b32 v197, 16, v197
    v_mul_f32 v199, v197, v197
    v_mov_b32 v200, 1.0
    v_fmac_f32 v200, 0x3d372713, v199
    v_mul_f32 v200, v200, v197
    v_mul_f32 v200, 0xc0135761, v200
    v_exp_f32 v200, v200
    s_nop 0
    v_add_f32 v200, 1.0, v200
    v_rcp_f32 v200, v200
    s_nop 0
    v_mul_f32 v200, v200, v197
    v_cvt_pk_bf16_f32 v200, v200, v200
    v_lshlrev_b32 v200, 16, v200
    v_mul_f32 v200, v200, v198
    v_cvt_pk_bf16_f32 v200, v200, v200
    ds_write_b16 v196, v200 offset:10752
    v_cvt_pk_bf16_f32 v197, v59, v123
    v_and_b32 v198, 0xffff0000, v197
    v_lshlrev_b32 v197, 16, v197
    v_mul_f32 v199, v197, v197
    v_mov_b32 v200, 1.0
    v_fmac_f32 v200, 0x3d372713, v199
    v_mul_f32 v200, v200, v197
    v_mul_f32 v200, 0xc0135761, v200
    v_exp_f32 v200, v200
    s_nop 0
    v_add_f32 v200, 1.0, v200
    v_rcp_f32 v200, v200
    s_nop 0
    v_mul_f32 v200, v200, v197
    v_cvt_pk_bf16_f32 v200, v200, v200
    v_lshlrev_b32 v200, 16, v200
    v_mul_f32 v200, v200, v198
    v_cvt_pk_bf16_f32 v200, v200, v200
    ds_write_b16 v196, v200 offset:11008
    v_cvt_pk_bf16_f32 v197, v60, v124
    v_and_b32 v198, 0xffff0000, v197
    v_lshlrev_b32 v197, 16, v197
    v_mul_f32 v199, v197, v197
    v_mov_b32 v200, 1.0
    v_fmac_f32 v200, 0x3d372713, v199
    v_mul_f32 v200, v200, v197
    v_mul_f32 v200, 0xc0135761, v200
    v_exp_f32 v200, v200
    s_nop 0
    v_add_f32 v200, 1.0, v200
    v_rcp_f32 v200, v200
    s_nop 0
    v_mul_f32 v200, v200, v197
    v_cvt_pk_bf16_f32 v200, v200, v200
    v_lshlrev_b32 v200, 16, v200
    v_mul_f32 v200, v200, v198
    v_cvt_pk_bf16_f32 v200, v200, v200
    ds_write_b16 v196, v200 offset:12288
    v_cvt_pk_bf16_f32 v197, v61, v125
    v_and_b32 v198, 0xffff0000, v197
    v_lshlrev_b32 v197, 16, v197
    v_mul_f32 v199, v197, v197
    v_mov_b32 v200, 1.0
    v_fmac_f32 v200, 0x3d372713, v199
    v_mul_f32 v200, v200, v197
    v_mul_f32 v200, 0xc0135761, v200
    v_exp_f32 v200, v200
    s_nop 0
    v_add_f32 v200, 1.0, v200
    v_rcp_f32 v200, v200
    s_nop 0
    v_mul_f32 v200, v200, v197
    v_cvt_pk_bf16_f32 v200, v200, v200
    v_lshlrev_b32 v200, 16, v200
    v_mul_f32 v200, v200, v198
    v_cvt_pk_bf16_f32 v200, v200, v200
    ds_write_b16 v196, v200 offset:12544
    v_cvt_pk_bf16_f32 v197, v62, v126
    v_and_b32 v198, 0xffff0000, v197
    v_lshlrev_b32 v197, 16, v197
    v_mul_f32 v199, v197, v197
    v_mov_b32 v200, 1.0
    v_fmac_f32 v200, 0x3d372713, v199
    v_mul_f32 v200, v200, v197
    v_mul_f32 v200, 0xc0135761, v200
    v_exp_f32 v200, v200
    s_nop 0
    v_add_f32 v200, 1.0, v200
    v_rcp_f32 v200, v200
    s_nop 0
    v_mul_f32 v200, v200, v197
    v_cvt_pk_bf16_f32 v200, v200, v200
    v_lshlrev_b32 v200, 16, v200
    v_mul_f32 v200, v200, v198
    v_cvt_pk_bf16_f32 v200, v200, v200
    ds_write_b16 v196, v200 offset:12800
    v_cvt_pk_bf16_f32 v197, v63, v127
    v_and_b32 v198, 0xffff0000, v197
    v_lshlrev_b32 v197, 16, v197
    v_mul_f32 v199, v197, v197
    v_mov_b32 v200, 1.0
    v_fmac_f32 v200, 0x3d372713, v199
    v_mul_f32 v200, v200, v197
    v_mul_f32 v200, 0xc0135761, v200
    v_exp_f32 v200, v200
    s_nop 0
    v_add_f32 v200, 1.0, v200
    v_rcp_f32 v200, v200
    s_nop 0
    v_mul_f32 v200, v200, v197
    v_cvt_pk_bf16_f32 v200, v200, v200
    v_lshlrev_b32 v200, 16, v200
    v_mul_f32 v200, v200, v198
    v_cvt_pk_bf16_f32 v200, v200, v200
    ds_write_b16 v196, v200 offset:13056
    v_cvt_pk_bf16_f32 v197, v64, v128
    v_and_b32 v198, 0xffff0000, v197
    v_lshlrev_b32 v197, 16, v197
    v_mul_f32 v199, v197, v197
    v_mov_b32 v200, 1.0
    v_fmac_f32 v200, 0x3d372713, v199
    v_mul_f32 v200, v200, v197
    v_mul_f32 v200, 0xc0135761, v200
    v_exp_f32 v200, v200
    s_nop 0
    v_add_f32 v200, 1.0, v200
    v_rcp_f32 v200, v200
    s_nop 0
    v_mul_f32 v200, v200, v197
    v_cvt_pk_bf16_f32 v200, v200, v200
    v_lshlrev_b32 v200, 16, v200
    v_mul_f32 v200, v200, v198
    v_cvt_pk_bf16_f32 v200, v200, v200
    ds_write_b16 v196, v200 offset:14336
    v_cvt_pk_bf16_f32 v197, v65, v129
    v_and_b32 v198, 0xffff0000, v197
    v_lshlrev_b32 v197, 16, v197
    v_mul_f32 v199, v197, v197
    v_mov_b32 v200, 1.0
    v_fmac_f32 v200, 0x3d372713, v199
    v_mul_f32 v200, v200, v197
    v_mul_f32 v200, 0xc0135761, v200
    v_exp_f32 v200, v200
    s_nop 0
    v_add_f32 v200, 1.0, v200
    v_rcp_f32 v200, v200
    s_nop 0
    v_mul_f32 v200, v200, v197
    v_cvt_pk_bf16_f32 v200, v200, v200
    v_lshlrev_b32 v200, 16, v200
    v_mul_f32 v200, v200, v198
    v_cvt_pk_bf16_f32 v200, v200, v200
    ds_write_b16 v196, v200 offset:14592
    v_cvt_pk_bf16_f32 v197, v66, v130
    v_and_b32 v198, 0xffff0000, v197
    v_lshlrev_b32 v197, 16, v197
    v_mul_f32 v199, v197, v197
    v_mov_b32 v200, 1.0
    v_fmac_f32 v200, 0x3d372713, v199
    v_mul_f32 v200, v200, v197
    v_mul_f32 v200, 0xc0135761, v200
    v_exp_f32 v200, v200
    s_nop 0
    v_add_f32 v200, 1.0, v200
    v_rcp_f32 v200, v200
    s_nop 0
    v_mul_f32 v200, v200, v197
    v_cvt_pk_bf16_f32 v200, v200, v200
    v_lshlrev_b32 v200, 16, v200
    v_mul_f32 v200, v200, v198
    v_cvt_pk_bf16_f32 v200, v200, v200
    ds_write_b16 v196, v200 offset:14848
    v_cvt_pk_bf16_f32 v197, v67, v131
    v_and_b32 v198, 0xffff0000, v197
    v_lshlrev_b32 v197, 16, v197
    v_mul_f32 v199, v197, v197
    v_mov_b32 v200, 1.0
    v_fmac_f32 v200, 0x3d372713, v199
    v_mul_f32 v200, v200, v197
    v_mul_f32 v200, 0xc0135761, v200
    v_exp_f32 v200, v200
    s_nop 0
    v_add_f32 v200, 1.0, v200
    v_rcp_f32 v200, v200
    s_nop 0
    v_mul_f32 v200, v200, v197
    v_cvt_pk_bf16_f32 v200, v200, v200
    v_lshlrev_b32 v200, 16, v200
    v_mul_f32 v200, v200, v198
    v_cvt_pk_bf16_f32 v200, v200, v200
    ds_write_b16 v196, v200 offset:15104
    v_cvt_pk_bf16_f32 v197, v68, v132
    v_and_b32 v198, 0xffff0000, v197
    v_lshlrev_b32 v197, 16, v197
    v_mul_f32 v199, v197, v197
    v_mov_b32 v200, 1.0
    v_fmac_f32 v200, 0x3d372713, v199
    v_mul_f32 v200, v200, v197
    v_mul_f32 v200, 0xc0135761, v200
    v_exp_f32 v200, v200
    s_nop 0
    v_add_f32 v200, 1.0, v200
    v_rcp_f32 v200, v200
    s_nop 0
    v_mul_f32 v200, v200, v197
    v_cvt_pk_bf16_f32 v200, v200, v200
    v_lshlrev_b32 v200, 16, v200
    v_mul_f32 v200, v200, v198
    v_cvt_pk_bf16_f32 v200, v200, v200
    ds_write_b16 v196, v200 offset:8256
    v_cvt_pk_bf16_f32 v197, v69, v133
    v_and_b32 v198, 0xffff0000, v197
    v_lshlrev_b32 v197, 16, v197
    v_mul_f32 v199, v197, v197
    v_mov_b32 v200, 1.0
    v_fmac_f32 v200, 0x3d372713, v199
    v_mul_f32 v200, v200, v197
    v_mul_f32 v200, 0xc0135761, v200
    v_exp_f32 v200, v200
    s_nop 0
    v_add_f32 v200, 1.0, v200
    v_rcp_f32 v200, v200
    s_nop 0
    v_mul_f32 v200, v200, v197
    v_cvt_pk_bf16_f32 v200, v200, v200
    v_lshlrev_b32 v200, 16, v200
    v_mul_f32 v200, v200, v198
    v_cvt_pk_bf16_f32 v200, v200, v200
    ds_write_b16 v196, v200 offset:8512
    v_cvt_pk_bf16_f32 v197, v70, v134
    v_and_b32 v198, 0xffff0000, v197
    v_lshlrev_b32 v197, 16, v197
    v_mul_f32 v199, v197, v197
    v_mov_b32 v200, 1.0
    v_fmac_f32 v200, 0x3d372713, v199
    v_mul_f32 v200, v200, v197
    v_mul_f32 v200, 0xc0135761, v200
    v_exp_f32 v200, v200
    s_nop 0
    v_add_f32 v200, 1.0, v200
    v_rcp_f32 v200, v200
    s_nop 0
    v_mul_f32 v200, v200, v197
    v_cvt_pk_bf16_f32 v200, v200, v200
    v_lshlrev_b32 v200, 16, v200
    v_mul_f32 v200, v200, v198
    v_cvt_pk_bf16_f32 v200, v200, v200
    ds_write_b16 v196, v200 offset:8768
    v_cvt_pk_bf16_f32 v197, v71, v135
    v_and_b32 v198, 0xffff0000, v197
    v_lshlrev_b32 v197, 16, v197
    v_mul_f32 v199, v197, v197
    v_mov_b32 v200, 1.0
    v_fmac_f32 v200, 0x3d372713, v199
    v_mul_f32 v200, v200, v197
    v_mul_f32 v200, 0xc0135761, v200
    v_exp_f32 v200, v200
    s_nop 0
    v_add_f32 v200, 1.0, v200
    v_rcp_f32 v200, v200
    s_nop 0
    v_mul_f32 v200, v200, v197
    v_cvt_pk_bf16_f32 v200, v200, v200
    v_lshlrev_b32 v200, 16, v200
    v_mul_f32 v200, v200, v198
    v_cvt_pk_bf16_f32 v200, v200, v200
    ds_write_b16 v196, v200 offset:9024
    v_cvt_pk_bf16_f32 v197, v72, v136
    v_and_b32 v198, 0xffff0000, v197
    v_lshlrev_b32 v197, 16, v197
    v_mul_f32 v199, v197, v197
    v_mov_b32 v200, 1.0
    v_fmac_f32 v200, 0x3d372713, v199
    v_mul_f32 v200, v200, v197
    v_mul_f32 v200, 0xc0135761, v200
    v_exp_f32 v200, v200
    s_nop 0
    v_add_f32 v200, 1.0, v200
    v_rcp_f32 v200, v200
    s_nop 0
    v_mul_f32 v200, v200, v197
    v_cvt_pk_bf16_f32 v200, v200, v200
    v_lshlrev_b32 v200, 16, v200
    v_mul_f32 v200, v200, v198
    v_cvt_pk_bf16_f32 v200, v200, v200
    ds_write_b16 v196, v200 offset:10304
    v_cvt_pk_bf16_f32 v197, v73, v137
    v_and_b32 v198, 0xffff0000, v197
    v_lshlrev_b32 v197, 16, v197
    v_mul_f32 v199, v197, v197
    v_mov_b32 v200, 1.0
    v_fmac_f32 v200, 0x3d372713, v199
    v_mul_f32 v200, v200, v197
    v_mul_f32 v200, 0xc0135761, v200
    v_exp_f32 v200, v200
    s_nop 0
    v_add_f32 v200, 1.0, v200
    v_rcp_f32 v200, v200
    s_nop 0
    v_mul_f32 v200, v200, v197
    v_cvt_pk_bf16_f32 v200, v200, v200
    v_lshlrev_b32 v200, 16, v200
    v_mul_f32 v200, v200, v198
    v_cvt_pk_bf16_f32 v200, v200, v200
    ds_write_b16 v196, v200 offset:10560
    v_cvt_pk_bf16_f32 v197, v74, v138
    v_and_b32 v198, 0xffff0000, v197
    v_lshlrev_b32 v197, 16, v197
    v_mul_f32 v199, v197, v197
    v_mov_b32 v200, 1.0
    v_fmac_f32 v200, 0x3d372713, v199
    v_mul_f32 v200, v200, v197
    v_mul_f32 v200, 0xc0135761, v200
    v_exp_f32 v200, v200
    s_nop 0
    v_add_f32 v200, 1.0, v200
    v_rcp_f32 v200, v200
    s_nop 0
    v_mul_f32 v200, v200, v197
    v_cvt_pk_bf16_f32 v200, v200, v200
    v_lshlrev_b32 v200, 16, v200
    v_mul_f32 v200, v200, v198
    v_cvt_pk_bf16_f32 v200, v200, v200
    ds_write_b16 v196, v200 offset:10816
    v_cvt_pk_bf16_f32 v197, v75, v139
    v_and_b32 v198, 0xffff0000, v197
    v_lshlrev_b32 v197, 16, v197
    v_mul_f32 v199, v197, v197
    v_mov_b32 v200, 1.0
    v_fmac_f32 v200, 0x3d372713, v199
    v_mul_f32 v200, v200, v197
    v_mul_f32 v200, 0xc0135761, v200
    v_exp_f32 v200, v200
    s_nop 0
    v_add_f32 v200, 1.0, v200
    v_rcp_f32 v200, v200
    s_nop 0
    v_mul_f32 v200, v200, v197
    v_cvt_pk_bf16_f32 v200, v200, v200
    v_lshlrev_b32 v200, 16, v200
    v_mul_f32 v200, v200, v198
    v_cvt_pk_bf16_f32 v200, v200, v200
    ds_write_b16 v196, v200 offset:11072
    v_cvt_pk_bf16_f32 v197, v76, v140
    v_and_b32 v198, 0xffff0000, v197
    v_lshlrev_b32 v197, 16, v197
    v_mul_f32 v199, v197, v197
    v_mov_b32 v200, 1.0
    v_fmac_f32 v200, 0x3d372713, v199
    v_mul_f32 v200, v200, v197
    v_mul_f32 v200, 0xc0135761, v200
    v_exp_f32 v200, v200
    s_nop 0
    v_add_f32 v200, 1.0, v200
    v_rcp_f32 v200, v200
    s_nop 0
    v_mul_f32 v200, v200, v197
    v_cvt_pk_bf16_f32 v200, v200, v200
    v_lshlrev_b32 v200, 16, v200
    v_mul_f32 v200, v200, v198
    v_cvt_pk_bf16_f32 v200, v200, v200
    ds_write_b16 v196, v200 offset:12352
    v_cvt_pk_bf16_f32 v197, v77, v141
    v_and_b32 v198, 0xffff0000, v197
    v_lshlrev_b32 v197, 16, v197
    v_mul_f32 v199, v197, v197
    v_mov_b32 v200, 1.0
    v_fmac_f32 v200, 0x3d372713, v199
    v_mul_f32 v200, v200, v197
    v_mul_f32 v200, 0xc0135761, v200
    v_exp_f32 v200, v200
    s_nop 0
    v_add_f32 v200, 1.0, v200
    v_rcp_f32 v200, v200
    s_nop 0
    v_mul_f32 v200, v200, v197
    v_cvt_pk_bf16_f32 v200, v200, v200
    v_lshlrev_b32 v200, 16, v200
    v_mul_f32 v200, v200, v198
    v_cvt_pk_bf16_f32 v200, v200, v200
    ds_write_b16 v196, v200 offset:12608
    v_cvt_pk_bf16_f32 v197, v78, v142
    v_and_b32 v198, 0xffff0000, v197
    v_lshlrev_b32 v197, 16, v197
    v_mul_f32 v199, v197, v197
    v_mov_b32 v200, 1.0
    v_fmac_f32 v200, 0x3d372713, v199
    v_mul_f32 v200, v200, v197
    v_mul_f32 v200, 0xc0135761, v200
    v_exp_f32 v200, v200
    s_nop 0
    v_add_f32 v200, 1.0, v200
    v_rcp_f32 v200, v200
    s_nop 0
    v_mul_f32 v200, v200, v197
    v_cvt_pk_bf16_f32 v200, v200, v200
    v_lshlrev_b32 v200, 16, v200
    v_mul_f32 v200, v200, v198
    v_cvt_pk_bf16_f32 v200, v200, v200
    ds_write_b16 v196, v200 offset:12864
    v_cvt_pk_bf16_f32 v197, v79, v143
    v_and_b32 v198, 0xffff0000, v197
    v_lshlrev_b32 v197, 16, v197
    v_mul_f32 v199, v197, v197
    v_mov_b32 v200, 1.0
    v_fmac_f32 v200, 0x3d372713, v199
    v_mul_f32 v200, v200, v197
    v_mul_f32 v200, 0xc0135761, v200
    v_exp_f32 v200, v200
    s_nop 0
    v_add_f32 v200, 1.0, v200
    v_rcp_f32 v200, v200
    s_nop 0
    v_mul_f32 v200, v200, v197
    v_cvt_pk_bf16_f32 v200, v200, v200
    v_lshlrev_b32 v200, 16, v200
    v_mul_f32 v200, v200, v198
    v_cvt_pk_bf16_f32 v200, v200, v200
    ds_write_b16 v196, v200 offset:13120
    v_cvt_pk_bf16_f32 v197, v80, v144
    v_and_b32 v198, 0xffff0000, v197
    v_lshlrev_b32 v197, 16, v197
    v_mul_f32 v199, v197, v197
    v_mov_b32 v200, 1.0
    v_fmac_f32 v200, 0x3d372713, v199
    v_mul_f32 v200, v200, v197
    v_mul_f32 v200, 0xc0135761, v200
    v_exp_f32 v200, v200
    s_nop 0
    v_add_f32 v200, 1.0, v200
    v_rcp_f32 v200, v200
    s_nop 0
    v_mul_f32 v200, v200, v197
    v_cvt_pk_bf16_f32 v200, v200, v200
    v_lshlrev_b32 v200, 16, v200
    v_mul_f32 v200, v200, v198
    v_cvt_pk_bf16_f32 v200, v200, v200
    ds_write_b16 v196, v200 offset:14400
    v_cvt_pk_bf16_f32 v197, v81, v145
    v_and_b32 v198, 0xffff0000, v197
    v_lshlrev_b32 v197, 16, v197
    v_mul_f32 v199, v197, v197
    v_mov_b32 v200, 1.0
    v_fmac_f32 v200, 0x3d372713, v199
    v_mul_f32 v200, v200, v197
    v_mul_f32 v200, 0xc0135761, v200
    v_exp_f32 v200, v200
    s_nop 0
    v_add_f32 v200, 1.0, v200
    v_rcp_f32 v200, v200
    s_nop 0
    v_mul_f32 v200, v200, v197
    v_cvt_pk_bf16_f32 v200, v200, v200
    v_lshlrev_b32 v200, 16, v200
    v_mul_f32 v200, v200, v198
    v_cvt_pk_bf16_f32 v200, v200, v200
    ds_write_b16 v196, v200 offset:14656
    v_cvt_pk_bf16_f32 v197, v82, v146
    v_and_b32 v198, 0xffff0000, v197
    v_lshlrev_b32 v197, 16, v197
    v_mul_f32 v199, v197, v197
    v_mov_b32 v200, 1.0
    v_fmac_f32 v200, 0x3d372713, v199
    v_mul_f32 v200, v200, v197
    v_mul_f32 v200, 0xc0135761, v200
    v_exp_f32 v200, v200
    s_nop 0
    v_add_f32 v200, 1.0, v200
    v_rcp_f32 v200, v200
    s_nop 0
    v_mul_f32 v200, v200, v197
    v_cvt_pk_bf16_f32 v200, v200, v200
    v_lshlrev_b32 v200, 16, v200
    v_mul_f32 v200, v200, v198
    v_cvt_pk_bf16_f32 v200, v200, v200
    ds_write_b16 v196, v200 offset:14912
    v_cvt_pk_bf16_f32 v197, v83, v147
    v_and_b32 v198, 0xffff0000, v197
    v_lshlrev_b32 v197, 16, v197
    v_mul_f32 v199, v197, v197
    v_mov_b32 v200, 1.0
    v_fmac_f32 v200, 0x3d372713, v199
    v_mul_f32 v200, v200, v197
    v_mul_f32 v200, 0xc0135761, v200
    v_exp_f32 v200, v200
    s_nop 0
    v_add_f32 v200, 1.0, v200
    v_rcp_f32 v200, v200
    s_nop 0
    v_mul_f32 v200, v200, v197
    v_cvt_pk_bf16_f32 v200, v200, v200
    v_lshlrev_b32 v200, 16, v200
    v_mul_f32 v200, v200, v198
    v_cvt_pk_bf16_f32 v200, v200, v200
    ds_write_b16 v196, v200 offset:15168
    s_waitcnt lgkmcnt(0)
    s_barrier
    v_lshrrev_b32 v197, 4, v0
    v_and_b32 v198, 15, v0
    v_lshlrev_b32 v199, 8, v197
    v_lshl_add_u32 v199, v198, 4, v199
    s_lshl_b32 s34, s30, 8
    v_add_u32 v197, s34, v197
    s_mov_b32 s35, 7168
    v_mul_lo_u32 v197, v197, s35
    v_lshl_add_u32 v197, v198, 4, v197
    s_lshl_b32 s34, s31, 8
    ds_read_b128 v[20:23], v199 offset:0
    ds_read_b128 v[24:27], v199 offset:8192
    ds_read_b128 v[28:31], v199 offset:16384
    ds_read_b128 v[32:35], v199 offset:24576
    ds_read_b128 v[36:39], v199 offset:32768
    ds_read_b128 v[40:43], v199 offset:40960
    ds_read_b128 v[44:47], v199 offset:49152
    ds_read_b128 v[48:51], v199 offset:57344
    s_waitcnt lgkmcnt(0)
    s_add_u32 s35, s34, 0
    buffer_store_dwordx4 v[20:23], v197, s[20:23], s35 offen
    s_add_u32 s35, s34, 229376
    buffer_store_dwordx4 v[24:27], v197, s[20:23], s35 offen
    s_add_u32 s35, s34, 458752
    buffer_store_dwordx4 v[28:31], v197, s[20:23], s35 offen
    s_add_u32 s35, s34, 688128
    buffer_store_dwordx4 v[32:35], v197, s[20:23], s35 offen
    s_add_u32 s35, s34, 917504
    buffer_store_dwordx4 v[36:39], v197, s[20:23], s35 offen
    s_add_u32 s35, s34, 1146880
    buffer_store_dwordx4 v[40:43], v197, s[20:23], s35 offen
    s_add_u32 s35, s34, 1376256
    buffer_store_dwordx4 v[44:47], v197, s[20:23], s35 offen
    s_add_u32 s35, s34, 1605632
    buffer_store_dwordx4 v[48:51], v197, s[20:23], s35 offen
    s_waitcnt vmcnt(0)
L_ffn1_done:
    s_endpgm
.globl fin_kernel
.p2align 8
.type fin_kernel,@function
fin_kernel:

    s_cmp_ge_u32 s2, 256
    s_cbranch_scc1 L_fin_done
    s_load_dwordx2 s[4:5], s[0:1], 40
    s_load_dwordx2 s[6:7], s[0:1], 48
    s_load_dwordx2 s[28:29], s[0:1], 120
    s_load_dwordx2 s[44:45], s[0:1], 96
    s_waitcnt lgkmcnt(0)
    s_mov_b32 s12, s4
    s_mov_b32 s13, s5
    s_mov_b32 s14, 2097152
    s_mov_b32 s15, 0x00020000
    s_mov_b32 s16, s6
    s_mov_b32 s17, s7
    s_mov_b32 s18, 2097152
    s_mov_b32 s19, 0x00020000
    s_mov_b32 s48, s44
    s_mov_b32 s49, s45
    s_mov_b32 s50, 7340032
    s_mov_b32 s51, 0x00020000
    s_add_u32 s36, s28, 33554432
    s_addc_u32 s37, s29, 0
    s_mov_b32 s8, s36
    s_mov_b32 s9, s37
    s_mov_b32 s10, 8388608
    s_mov_b32 s11, 0x00020000
    s_add_u32 s36, s28, 50331648
    s_addc_u32 s37, s29, 0
    s_mov_b32 s52, s36
    s_mov_b32 s53, s37
    s_mov_b32 s54, 14680064
    s_mov_b32 s55, 0x00020000
    v_lshrrev_b32 v1, 6, v0
    s_nop 0
    v_readfirstlane_b32 s3, v1
    v_and_b32 v1, 63, v0
    s_lshl_b32 s4, s3, 10
    s_and_b32 s30, s2, 15
    s_lshr_b32 s31, s2, 4
    s_lshl_b32 s24, s30, 8
    s_mul_i32 s25, s31, 64*2048
    s_mov_b32 s26, s25
    s_mul_i32 s27, s30, 128*7168
    s_lshl_b32 s38, s31, 7
    s_and_b32 s32, s3, 1
    s_lshl_b32 s32, s32, 6
    s_lshr_b32 s33, s3, 1
    s_lshl_b32 s33, s33, 5
    v_lshrrev_b32 v2, 4, v1
    v_and_b32 v3, 15, v1
    v_and_b32 v4, 3, v2
    v_lshlrev_b32 v4, 2, v4
    v_xor_b32 v3, v3, v4
    v_lshlrev_b32 v3, 4, v3
    s_mul_i32 s90, s3, 4
    v_add_u32 v2, s90, v2
    s_mov_b32 s90, 4096
    v_mul_lo_u32 v2, v2, s90
    v_add_u32 v8, v2, v3
    v_lshrrev_b32 v2, 3, v1
    v_and_b32 v3, 7, v1
    v_lshrrev_b32 v4, 1, v2
    s_and_b32 s90, s3, 1
    s_lshl_b32 s90, s90, 2
    v_add_u32 v4, s90, v4
    v_xor_b32 v3, v3, v4
    v_lshlrev_b32 v3, 4, v3
    s_lshl_b32 s90, s3, 3
    v_add_u32 v2, s90, v2
    s_mov_b32 s90, 2048
    v_mul_lo_u32 v2, v2, s90
    v_add_u32 v9, v2, v3
    v_lshrrev_b32 v2, 3, v1
    v_and_b32 v3, 7, v1
    v_lshrrev_b32 v4, 1, v2
    s_and_b32 s90, s3, 1
    s_lshl_b32 s90, s90, 2
    v_add_u32 v4, s90, v4
    v_xor_b32 v3, v3, v4
    v_lshlrev_b32 v3, 4, v3
    s_lshl_b32 s90, s3, 3
    v_add_u32 v2, s90, v2
    s_mov_b32 s90, 7168
    v_mul_lo_u32 v2, v2, s90
    v_add_u32 v10, v2, v3
    v_lshrrev_b32 v2, 3, v1
    v_and_b32 v3, 7, v1
    v_lshrrev_b32 v4, 1, v2
    v_and_b32 v4, 1, v4
    v_lshlrev_b32 v4, 2, v4
    v_xor_b32 v3, v3, v4
    v_lshlrev_b32 v3, 4, v3
    s_mul_i32 s90, s3, 8
    v_add_u32 v2, s90, v2
    s_mov_b32 s90, 2048
    v_mul_lo_u32 v2, v2, s90
    v_add_u32 v11, v2, v3
    v_and_b32 v2, 15, v1
    v_lshrrev_b32 v3, 2, v2
    v_and_b32 v2, 3, v2
    v_lshlrev_b32 v2, 3, v2
    v_lshrrev_b32 v4, 4, v1
    v_and_b32 v4, 1, v4
    v_lshl_add_u32 v2, v4, 5, v2
    s_lshl_b32 s90, s32, 1
    s_add_u32 s90, s90, 0
    v_add_u32 v12, s90, v2
    v_lshlrev_b32 v4, 6, v3
    v_xor_b32 v12, v12, v4
    v_lshrrev_b32 v4, 5, v1
    v_lshl_add_u32 v4, v4, 3, v3
    v_lshlrev_b32 v4, 8, v4
    v_add_u32 v12, v12, v4
    s_lshl_b32 s90, s32, 1
    s_add_u32 s90, s90, 64
    v_add_u32 v13, s90, v2
    v_lshlrev_b32 v4, 6, v3
    v_xor_b32 v13, v13, v4
    v_lshrrev_b32 v4, 5, v1
    v_lshl_add_u32 v4, v4, 3, v3
    v_lshlrev_b32 v4, 8, v4
    v_add_u32 v13, v13, v4
    v_and_b32 v2, 31, v1
    v_lshrrev_b32 v3, 5, v1
    v_lshrrev_b32 v4, 1, v2
    v_and_b32 v4, 7, v4
    v_add_u32 v2, s33, v2
    v_lshlrev_b32 v2, 7, v2
    v_add_u32 v14, 0, v3
    v_xor_b32 v14, v14, v4
    v_lshlrev_b32 v14, 4, v14
    v_add_u32 v14, v14, v2
    v_add_u32 v14, 16384, v14
    v_add_u32 v15, 2, v3
    v_xor_b32 v15, v15, v4
    v_lshlrev_b32 v15, 4, v15
    v_add_u32 v15, v15, v2
    v_add_u32 v15, 16384, v15
    v_add_u32 v16, 4, v3
    v_xor_b32 v16, v16, v4
    v_lshlrev_b32 v16, 4, v16
    v_add_u32 v16, v16, v2
    v_add_u32 v16, 16384, v16
    v_add_u32 v17, 6, v3
    v_xor_b32 v17, v17, v4
    v_lshlrev_b32 v17, 4, v17
    v_add_u32 v17, v17, v2
    v_add_u32 v17, 16384, v17
    v_and_b32 v2, 31, v1
    v_lshrrev_b32 v3, 5, v1
    v_lshrrev_b32 v4, 1, v2
    v_and_b32 v4, 7, v4
    v_add_u32 v2, s32, v2
    v_lshlrev_b32 v2, 7, v2
    v_add_u32 v18, 0, v3
    v_xor_b32 v18, v18, v4
    v_lshlrev_b32 v18, 4, v18
    v_add_u32 v18, v18, v2
    v_add_u32 v19, 2, v3
    v_xor_b32 v19, v19, v4
    v_lshlrev_b32 v19, 4, v19
    v_add_u32 v19, v19, v2
    v_add_u32 v20, 4, v3
    v_xor_b32 v20, v20, v4
    v_lshlrev_b32 v20, 4, v20
    v_add_u32 v20, v20, v2
    v_add_u32 v21, 6, v3
    v_xor_b32 v21, v21, v4
    v_lshlrev_b32 v21, 4, v21
    v_add_u32 v21, v21, v2
    v_and_b32 v2, 15, v1
    v_lshrrev_b32 v3, 2, v2
    v_and_b32 v2, 3, v2
    v_lshlrev_b32 v2, 3, v2
    v_lshrrev_b32 v4, 4, v1
    v_and_b32 v4, 1, v4
    v_lshl_add_u32 v2, v4, 5, v2
    s_lshl_b32 s90, s33, 1
    s_add_u32 s90, s90, 0
    v_add_u32 v22, s90, v2
    v_lshrrev_b32 v4, 1, v3
    v_lshlrev_b32 v4, 6, v4
    v_xor_b32 v22, v22, v4
    v_lshrrev_b32 v4, 5, v1
    v_lshl_add_u32 v4, v4, 3, v3
    v_lshlrev_b32 v4, 7, v4
    v_add_u32 v22, v22, v4
    v_add_u32 v22, 16384, v22
    v_mov_b32 v24, 0
    v_mov_b32 v25, 0
    v_mov_b32 v26, 0
    v_mov_b32 v27, 0
    v_mov_b32 v28, 0
    v_mov_b32 v29, 0
    v_mov_b32 v30, 0
    v_mov_b32 v31, 0
    v_mov_b32 v32, 0
    v_mov_b32 v33, 0
    v_mov_b32 v34, 0
    v_mov_b32 v35, 0
    v_mov_b32 v36, 0
    v_mov_b32 v37, 0
    v_mov_b32 v38, 0
    v_mov_b32 v39, 0
    v_mov_b32 v40, 0
    v_mov_b32 v41, 0
    v_mov_b32 v42, 0
    v_mov_b32 v43, 0
    v_mov_b32 v44, 0
    v_mov_b32 v45, 0
    v_mov_b32 v46, 0
    v_mov_b32 v47, 0
    v_mov_b32 v48, 0
    v_mov_b32 v49, 0
    v_mov_b32 v50, 0
    v_mov_b32 v51, 0
    v_mov_b32 v52, 0
    v_mov_b32 v53, 0
    v_mov_b32 v54, 0
    v_mov_b32 v55, 0
    v_mov_b32 v56, 0
    v_mov_b32 v57, 0
    v_mov_b32 v58, 0
    v_mov_b32 v59, 0
    v_mov_b32 v60, 0
    v_mov_b32 v61, 0
    v_mov_b32 v62, 0
    v_mov_b32 v63, 0
    v_mov_b32 v64, 0
    v_mov_b32 v65, 0
    v_mov_b32 v66, 0
    v_mov_b32 v67, 0
    v_mov_b32 v68, 0
    v_mov_b32 v69, 0
    v_mov_b32 v70, 0
    v_mov_b32 v71, 0
    v_mov_b32 v72, 0
    v_mov_b32 v73, 0
    v_mov_b32 v74, 0
    v_mov_b32 v75, 0
    v_mov_b32 v76, 0
    v_mov_b32 v77, 0
    v_mov_b32 v78, 0
    v_mov_b32 v79, 0
    v_mov_b32 v80, 0
    v_mov_b32 v81, 0
    v_mov_b32 v82, 0
    v_mov_b32 v83, 0
    v_mov_b32 v84, 0
    v_mov_b32 v85, 0
    v_mov_b32 v86, 0
    v_mov_b32 v87, 0
    s_add_u32 m0, s4, 0
    s_nop 0
    buffer_load_dwordx4 v8, s[8:11], s24 offen lds
    s_add_u32 m0, s4, 4096
    s_add_u32 s91, s24, 65536
    buffer_load_dwordx4 v8, s[8:11], s91 offen lds
    s_add_u32 m0, s4, 8192
    s_add_u32 s91, s24, 131072
    buffer_load_dwordx4 v8, s[8:11], s91 offen lds
    s_add_u32 m0, s4, 12288
    s_add_u32 s91, s24, 196608
    buffer_load_dwordx4 v8, s[8:11], s91 offen lds
    s_add_u32 m0, s4, 16384
    s_nop 0
    buffer_load_dwordx4 v9, s[12:15], s25 offen lds
    s_add_u32 m0, s4, 20480
    s_add_u32 s91, s25, 65536
    buffer_load_dwordx4 v9, s[12:15], s91 offen lds
    s_add_u32 s24, s24, 262144
    s_add_u32 s25, s25, 128
    s_add_u32 m0, s4, 24576
    s_nop 0
    buffer_load_dwordx4 v8, s[8:11], s24 offen lds
    s_add_u32 m0, s4, 28672
    s_add_u32 s91, s24, 65536
    buffer_load_dwordx4 v8, s[8:11], s91 offen lds
    s_add_u32 m0, s4, 32768
    s_add_u32 s91, s24, 131072
    buffer_load_dwordx4 v8, s[8:11], s91 offen lds
    s_add_u32 m0, s4, 36864
    s_add_u32 s91, s24, 196608
    buffer_load_dwordx4 v8, s[8:11], s91 offen lds
    s_add_u32 m0, s4, 40960
    s_nop 0
    buffer_load_dwordx4 v9, s[12:15], s25 offen lds
    s_add_u32 m0, s4, 45056
    s_add_u32 s91, s25, 65536
    buffer_load_dwordx4 v9, s[12:15], s91 offen lds
    s_add_u32 s24, s24, 262144
    s_add_u32 s25, s25, 128
    s_add_u32 m0, s4, 49152
    s_nop 0
    buffer_load_dwordx4 v8, s[8:11], s24 offen lds
    s_add_u32 m0, s4, 53248
    s_add_u32 s91, s24, 65536
    buffer_load_dwordx4 v8, s[8:11], s91 offen lds
    s_add_u32 m0, s4, 57344
    s_add_u32 s91, s24, 131072
    buffer_load_dwordx4 v8, s[8:11], s91 offen lds
    s_add_u32 m0, s4, 61440
    s_add_u32 s91, s24, 196608
    buffer_load_dwordx4 v8, s[8:11], s91 offen lds
    s_add_u32 m0, s4, 65536
    s_nop 0
    buffer_load_dwordx4 v9, s[12:15], s25 offen lds
    s_add_u32 m0, s4, 69632
    s_add_u32 s91, s25, 65536
    buffer_load_dwordx4 v9, s[12:15], s91 offen lds
    s_add_u32 s24, s24, 262144
    s_add_u32 s25, s25, 128
    s_mov_b32 s92, 3
L_k_3:
    s_waitcnt vmcnt(12)
    s_barrier
    ds_read_b64_tr_b16 v[88:89], v12 offset:0
    ds_read_b64_tr_b16 v[90:91], v12 offset:1024
    ds_read_b64_tr_b16 v[92:93], v13 offset:0
    ds_read_b64_tr_b16 v[94:95], v13 offset:1024
    ds_read_b128 v[96:99], v14 offset:0
    s_add_u32 m0, s4, 73728
    s_nop 0
    buffer_load_dwordx4 v8, s[8:11], s24 offen lds
    s_add_u32 m0, s4, 77824
    s_add_u32 s91, s24, 65536
    buffer_load_dwordx4 v8, s[8:11], s91 offen lds
    s_add_u32 m0, s4, 81920
    s_add_u32 s91, s24, 131072
    buffer_load_dwordx4 v8, s[8:11], s91 offen lds
    s_add_u32 m0, s4, 86016
    s_add_u32 s91, s24, 196608
    buffer_load_dwordx4 v8, s[8:11], s91 offen lds
    s_add_u32 m0, s4, 90112
    s_nop 0
    buffer_load_dwordx4 v9, s[12:15], s25 offen lds
    s_add_u32 m0, s4, 94208
    s_add_u32 s91, s25, 65536
    buffer_load_dwordx4 v9, s[12:15], s91 offen lds
    s_add_u32 s24, s24, 262144
    s_add_u32 s25, s25, 128
    ds_read_b64_tr_b16 v[100:101], v12 offset:4096
    ds_read_b64_tr_b16 v[102:103], v12 offset:5120
    ds_read_b64_tr_b16 v[104:105], v13 offset:4096
    ds_read_b64_tr_b16 v[106:107], v13 offset:5120
    ds_read_b128 v[108:111], v15 offset:0
    s_waitcnt lgkmcnt(5)
    v_mfma_f32_32x32x16_bf16 v[24:39], v[88:91], v[96:99], v[24:39]
    v_mfma_f32_32x32x16_bf16 v[40:55], v[92:95], v[96:99], v[40:55]
    ds_read_b64_tr_b16 v[88:89], v12 offset:8192
    ds_read_b64_tr_b16 v[90:91], v12 offset:9216
    ds_read_b64_tr_b16 v[92:93], v13 offset:8192
    ds_read_b64_tr_b16 v[94:95], v13 offset:9216
    ds_read_b128 v[96:99], v16 offset:0
    s_waitcnt lgkmcnt(5)
    v_mfma_f32_32x32x16_bf16 v[24:39], v[100:103], v[108:111], v[24:39]
    v_mfma_f32_32x32x16_bf16 v[40:55], v[104:107], v[108:111], v[40:55]
    ds_read_b64_tr_b16 v[100:101], v12 offset:12288
    ds_read_b64_tr_b16 v[102:103], v12 offset:13312
    ds_read_b64_tr_b16 v[104:105], v13 offset:12288
    ds_read_b64_tr_b16 v[106:107], v13 offset:13312
    ds_read_b128 v[108:111], v17 offset:0
    s_waitcnt lgkmcnt(5)
    v_mfma_f32_32x32x16_bf16 v[24:39], v[88:91], v[96:99], v[24:39]
    v_mfma_f32_32x32x16_bf16 v[40:55], v[92:95], v[96:99], v[40:55]
    s_waitcnt lgkmcnt(0)
    v_mfma_f32_32x32x16_bf16 v[24:39], v[100:103], v[108:111], v[24:39]
    v_mfma_f32_32x32x16_bf16 v[40:55], v[104:107], v[108:111], v[40:55]
    s_waitcnt vmcnt(12)
    s_barrier
    v_add_u32 v12, 24576, v12
    v_add_u32 v13, 24576, v13
    v_add_u32 v14, 24576, v14
    v_add_u32 v15, 24576, v15
    v_add_u32 v16, 24576, v16
    v_add_u32 v17, 24576, v17
    v_add_u32 v18, 24576, v18
    v_add_u32 v19, 24576, v19
    v_add_u32 v20, 24576, v20
    v_add_u32 v21, 24576, v21
    v_add_u32 v22, 24576, v22
    ds_read_b64_tr_b16 v[88:89], v12 offset:0
    ds_read_b64_tr_b16 v[90:91], v12 offset:1024
    ds_read_b64_tr_b16 v[92:93], v13 offset:0
    ds_read_b64_tr_b16 v[94:95], v13 offset:1024
    ds_read_b128 v[96:99], v14 offset:0
    s_add_u32 m0, s4, 0
    s_nop 0
    buffer_load_dwordx4 v8, s[8:11], s24 offen lds
    s_add_u32 m0, s4, 4096
    s_add_u32 s91, s24, 65536
    buffer_load_dwordx4 v8, s[8:11], s91 offen lds
    s_add_u32 m0, s4, 8192
    s_add_u32 s91, s24, 131072
    buffer_load_dwordx4 v8, s[8:11], s91 offen lds
    s_add_u32 m0, s4, 12288
    s_add_u32 s91, s24, 196608
    buffer_load_dwordx4 v8, s[8:11], s91 offen lds
    s_add_u32 m0, s4, 16384
    s_nop 0
    buffer_load_dwordx4 v9, s[12:15], s25 offen lds
    s_add_u32 m0, s4, 20480
    s_add_u32 s91, s25, 65536
    buffer_load_dwordx4 v9, s[12:15], s91 offen lds
    s_add_u32 s24, s24, 262144
    s_add_u32 s25, s25, 128
    ds_read_b64_tr_b16 v[100:101], v12 offset:4096
    ds_read_b64_tr_b16 v[102:103], v12 offset:5120
    ds_read_b64_tr_b16 v[104:105], v13 offset:4096
    ds_read_b64_tr_b16 v[106:107], v13 offset:5120
    ds_read_b128 v[108:111], v15 offset:0
    s_waitcnt lgkmcnt(5)
    v_mfma_f32_32x32x16_bf16 v[24:39], v[88:91], v[96:99], v[24:39]
    v_mfma_f32_32x32x16_bf16 v[40:55], v[92:95], v[96:99], v[40:55]
    ds_read_b64_tr_b16 v[88:89], v12 offset:8192
    ds_read_b64_tr_b16 v[90:91], v12 offset:9216
    ds_read_b64_tr_b16 v[92:93], v13 offset:8192
    ds_read_b64_tr_b16 v[94:95], v13 offset:9216
    ds_read_b128 v[96:99], v16 offset:0
    s_waitcnt lgkmcnt(5)
    v_mfma_f32_32x32x16_bf16 v[24:39], v[100:103], v[108:111], v[24:39]
    v_mfma_f32_32x32x16_bf16 v[40:55], v[104:107], v[108:111], v[40:55]
    ds_read_b64_tr_b16 v[100:101], v12 offset:12288
    ds_read_b64_tr_b16 v[102:103], v12 offset:13312
    ds_read_b64_tr_b16 v[104:105], v13 offset:12288
    ds_read_b64_tr_b16 v[106:107], v13 offset:13312
    ds_read_b128 v[108:111], v17 offset:0
    s_waitcnt lgkmcnt(5)
    v_mfma_f32_32x32x16_bf16 v[24:39], v[88:91], v[96:99], v[24:39]
    v_mfma_f32_32x32x16_bf16 v[40:55], v[92:95], v[96:99], v[40:55]
    s_waitcnt lgkmcnt(0)
    v_mfma_f32_32x32x16_bf16 v[24:39], v[100:103], v[108:111], v[24:39]
    v_mfma_f32_32x32x16_bf16 v[40:55], v[104:107], v[108:111], v[40:55]
    s_waitcnt vmcnt(12)
    s_barrier
    v_add_u32 v12, 24576, v12
    v_add_u32 v13, 24576, v13
    v_add_u32 v14, 24576, v14
    v_add_u32 v15, 24576, v15
    v_add_u32 v16, 24576, v16
    v_add_u32 v17, 24576, v17
    v_add_u32 v18, 24576, v18
    v_add_u32 v19, 24576, v19
    v_add_u32 v20, 24576, v20
    v_add_u32 v21, 24576, v21
    v_add_u32 v22, 24576, v22
    ds_read_b64_tr_b16 v[88:89], v12 offset:0
    ds_read_b64_tr_b16 v[90:91], v12 offset:1024
    ds_read_b64_tr_b16 v[92:93], v13 offset:0
    ds_read_b64_tr_b16 v[94:95], v13 offset:1024
    ds_read_b128 v[96:99], v14 offset:0
    s_add_u32 m0, s4, 24576
    s_nop 0
    buffer_load_dwordx4 v8, s[8:11], s24 offen lds
    s_add_u32 m0, s4, 28672
    s_add_u32 s91, s24, 65536
    buffer_load_dwordx4 v8, s[8:11], s91 offen lds
    s_add_u32 m0, s4, 32768
    s_add_u32 s91, s24, 131072
    buffer_load_dwordx4 v8, s[8:11], s91 offen lds
    s_add_u32 m0, s4, 36864
    s_add_u32 s91, s24, 196608
    buffer_load_dwordx4 v8, s[8:11], s91 offen lds
    s_add_u32 m0, s4, 40960
    s_nop 0
    buffer_load_dwordx4 v9, s[12:15], s25 offen lds
    s_add_u32 m0, s4, 45056
    s_add_u32 s91, s25, 65536
    buffer_load_dwordx4 v9, s[12:15], s91 offen lds
    s_add_u32 s24, s24, 262144
    s_add_u32 s25, s25, 128
    ds_read_b64_tr_b16 v[100:101], v12 offset:4096
    ds_read_b64_tr_b16 v[102:103], v12 offset:5120
    ds_read_b64_tr_b16 v[104:105], v13 offset:4096
    ds_read_b64_tr_b16 v[106:107], v13 offset:5120
    ds_read_b128 v[108:111], v15 offset:0
    s_waitcnt lgkmcnt(5)
    v_mfma_f32_32x32x16_bf16 v[24:39], v[88:91], v[96:99], v[24:39]
    v_mfma_f32_32x32x16_bf16 v[40:55], v[92:95], v[96:99], v[40:55]
    ds_read_b64_tr_b16 v[88:89], v12 offset:8192
    ds_read_b64_tr_b16 v[90:91], v12 offset:9216
    ds_read_b64_tr_b16 v[92:93], v13 offset:8192
    ds_read_b64_tr_b16 v[94:95], v13 offset:9216
    ds_read_b128 v[96:99], v16 offset:0
    s_waitcnt lgkmcnt(5)
    v_mfma_f32_32x32x16_bf16 v[24:39], v[100:103], v[108:111], v[24:39]
    v_mfma_f32_32x32x16_bf16 v[40:55], v[104:107], v[108:111], v[40:55]
    ds_read_b64_tr_b16 v[100:101], v12 offset:12288
    ds_read_b64_tr_b16 v[102:103], v12 offset:13312
    ds_read_b64_tr_b16 v[104:105], v13 offset:12288
    ds_read_b64_tr_b16 v[106:107], v13 offset:13312
    ds_read_b128 v[108:111], v17 offset:0
    s_waitcnt lgkmcnt(5)
    v_mfma_f32_32x32x16_bf16 v[24:39], v[88:91], v[96:99], v[24:39]
    v_mfma_f32_32x32x16_bf16 v[40:55], v[92:95], v[96:99], v[40:55]
    s_waitcnt lgkmcnt(0)
    v_mfma_f32_32x32x16_bf16 v[24:39], v[100:103], v[108:111], v[24:39]
    v_mfma_f32_32x32x16_bf16 v[40:55], v[104:107], v[108:111], v[40:55]
    s_waitcnt vmcnt(12)
    s_barrier
    v_add_u32 v12, 24576, v12
    v_add_u32 v13, 24576, v13
    v_add_u32 v14, 24576, v14
    v_add_u32 v15, 24576, v15
    v_add_u32 v16, 24576, v16
    v_add_u32 v17, 24576, v17
    v_add_u32 v18, 24576, v18
    v_add_u32 v19, 24576, v19
    v_add_u32 v20, 24576, v20
    v_add_u32 v21, 24576, v21
    v_add_u32 v22, 24576, v22
    ds_read_b64_tr_b16 v[88:89], v12 offset:0
    ds_read_b64_tr_b16 v[90:91], v12 offset:1024
    ds_read_b64_tr_b16 v[92:93], v13 offset:0
    ds_read_b64_tr_b16 v[94:95], v13 offset:1024
    ds_read_b128 v[96:99], v14 offset:0
    s_add_u32 m0, s4, 49152
    s_nop 0
    buffer_load_dwordx4 v8, s[8:11], s24 offen lds
    s_add_u32 m0, s4, 53248
    s_add_u32 s91, s24, 65536
    buffer_load_dwordx4 v8, s[8:11], s91 offen lds
    s_add_u32 m0, s4, 57344
    s_add_u32 s91, s24, 131072
    buffer_load_dwordx4 v8, s[8:11], s91 offen lds
    s_add_u32 m0, s4, 61440
    s_add_u32 s91, s24, 196608
    buffer_load_dwordx4 v8, s[8:11], s91 offen lds
    s_add_u32 m0, s4, 65536
    s_nop 0
    buffer_load_dwordx4 v9, s[12:15], s25 offen lds
    s_add_u32 m0, s4, 69632
    s_add_u32 s91, s25, 65536
    buffer_load_dwordx4 v9, s[12:15], s91 offen lds
    s_add_u32 s24, s24, 262144
    s_add_u32 s25, s25, 128
    ds_read_b64_tr_b16 v[100:101], v12 offset:4096
    ds_read_b64_tr_b16 v[102:103], v12 offset:5120
    ds_read_b64_tr_b16 v[104:105], v13 offset:4096
    ds_read_b64_tr_b16 v[106:107], v13 offset:5120
    ds_read_b128 v[108:111], v15 offset:0
    s_waitcnt lgkmcnt(5)
    v_mfma_f32_32x32x16_bf16 v[24:39], v[88:91], v[96:99], v[24:39]
    v_mfma_f32_32x32x16_bf16 v[40:55], v[92:95], v[96:99], v[40:55]
    ds_read_b64_tr_b16 v[88:89], v12 offset:8192
    ds_read_b64_tr_b16 v[90:91], v12 offset:9216
    ds_read_b64_tr_b16 v[92:93], v13 offset:8192
    ds_read_b64_tr_b16 v[94:95], v13 offset:9216
    ds_read_b128 v[96:99], v16 offset:0
    s_waitcnt lgkmcnt(5)
    v_mfma_f32_32x32x16_bf16 v[24:39], v[100:103], v[108:111], v[24:39]
    v_mfma_f32_32x32x16_bf16 v[40:55], v[104:107], v[108:111], v[40:55]
    ds_read_b64_tr_b16 v[100:101], v12 offset:12288
    ds_read_b64_tr_b16 v[102:103], v12 offset:13312
    ds_read_b64_tr_b16 v[104:105], v13 offset:12288
    ds_read_b64_tr_b16 v[106:107], v13 offset:13312
    ds_read_b128 v[108:111], v17 offset:0
    s_waitcnt lgkmcnt(5)
    v_mfma_f32_32x32x16_bf16 v[24:39], v[88:91], v[96:99], v[24:39]
    v_mfma_f32_32x32x16_bf16 v[40:55], v[92:95], v[96:99], v[40:55]
    s_waitcnt lgkmcnt(0)
    v_mfma_f32_32x32x16_bf16 v[24:39], v[100:103], v[108:111], v[24:39]
    v_mfma_f32_32x32x16_bf16 v[40:55], v[104:107], v[108:111], v[40:55]
    v_subrev_u32 v12, 73728, v12
    v_subrev_u32 v13, 73728, v13
    v_subrev_u32 v14, 73728, v14
    v_subrev_u32 v15, 73728, v15
    v_subrev_u32 v16, 73728, v16
    v_subrev_u32 v17, 73728, v17
    v_subrev_u32 v18, 73728, v18
    v_subrev_u32 v19, 73728, v19
    v_subrev_u32 v20, 73728, v20
    v_subrev_u32 v21, 73728, v21
    v_subrev_u32 v22, 73728, v22
    s_sub_u32 s92, s92, 1
    s_cmp_lg_u32 s92, 0
    s_cbranch_scc1 L_k_3
    s_waitcnt vmcnt(12)
    s_barrier
    ds_read_b64_tr_b16 v[88:89], v12 offset:0
    ds_read_b64_tr_b16 v[90:91], v12 offset:1024
    ds_read_b64_tr_b16 v[92:93], v13 offset:0
    ds_read_b64_tr_b16 v[94:95], v13 offset:1024
    ds_read_b128 v[96:99], v14 offset:0
    s_add_u32 m0, s4, 73728
    s_nop 0
    buffer_load_dwordx4 v8, s[8:11], s24 offen lds
    s_add_u32 m0, s4, 77824
    s_add_u32 s91, s24, 65536
    buffer_load_dwordx4 v8, s[8:11], s91 offen lds
    s_add_u32 m0, s4, 81920
    s_add_u32 s91, s24, 131072
    buffer_load_dwordx4 v8, s[8:11], s91 offen lds
    s_add_u32 m0, s4, 86016
    s_add_u32 s91, s24, 196608
    buffer_load_dwordx4 v8, s[8:11], s91 offen lds
    s_add_u32 m0, s4, 90112
    s_nop 0
    buffer_load_dwordx4 v9, s[12:15], s25 offen lds
    s_add_u32 m0, s4, 94208
    s_add_u32 s91, s25, 65536
    buffer_load_dwordx4 v9, s[12:15], s91 offen lds
    s_add_u32 s24, s24, 262144
    s_add_u32 s25, s25, 128
    ds_read_b64_tr_b16 v[100:101], v12 offset:4096
    ds_read_b64_tr_b16 v[102:103], v12 offset:5120
    ds_read_b64_tr_b16 v[104:105], v13 offset:4096
    ds_read_b64_tr_b16 v[106:107], v13 offset:5120
    ds_read_b128 v[108:111], v15 offset:0
    s_waitcnt lgkmcnt(5)
    v_mfma_f32_32x32x16_bf16 v[24:39], v[88:91], v[96:99], v[24:39]
    v_mfma_f32_32x32x16_bf16 v[40:55], v[92:95], v[96:99], v[40:55]
    ds_read_b64_tr_b16 v[88:89], v12 offset:8192
    ds_read_b64_tr_b16 v[90:91], v12 offset:9216
    ds_read_b64_tr_b16 v[92:93], v13 offset:8192
    ds_read_b64_tr_b16 v[94:95], v13 offset:9216
    ds_read_b128 v[96:99], v16 offset:0
    s_waitcnt lgkmcnt(5)
    v_mfma_f32_32x32x16_bf16 v[24:39], v[100:103], v[108:111], v[24:39]
    v_mfma_f32_32x32x16_bf16 v[40:55], v[104:107], v[108:111], v[40:55]
    ds_read_b64_tr_b16 v[100:101], v12 offset:12288
    ds_read_b64_tr_b16 v[102:103], v12 offset:13312
    ds_read_b64_tr_b16 v[104:105], v13 offset:12288
    ds_read_b64_tr_b16 v[106:107], v13 offset:13312
    ds_read_b128 v[108:111], v17 offset:0
    s_waitcnt lgkmcnt(5)
    v_mfma_f32_32x32x16_bf16 v[24:39], v[88:91], v[96:99], v[24:39]
    v_mfma_f32_32x32x16_bf16 v[40:55], v[92:95], v[96:99], v[40:55]
    s_waitcnt lgkmcnt(0)
    v_mfma_f32_32x32x16_bf16 v[24:39], v[100:103], v[108:111], v[24:39]
    v_mfma_f32_32x32x16_bf16 v[40:55], v[104:107], v[108:111], v[40:55]
    s_waitcnt vmcnt(12)
    s_barrier
    v_add_u32 v12, 24576, v12
    v_add_u32 v13, 24576, v13
    v_add_u32 v14, 24576, v14
    v_add_u32 v15, 24576, v15
    v_add_u32 v16, 24576, v16
    v_add_u32 v17, 24576, v17
    v_add_u32 v18, 24576, v18
    v_add_u32 v19, 24576, v19
    v_add_u32 v20, 24576, v20
    v_add_u32 v21, 24576, v21
    v_add_u32 v22, 24576, v22
    ds_read_b64_tr_b16 v[88:89], v12 offset:0
    ds_read_b64_tr_b16 v[90:91], v12 offset:1024
    ds_read_b64_tr_b16 v[92:93], v13 offset:0
    ds_read_b64_tr_b16 v[94:95], v13 offset:1024
    ds_read_b128 v[96:99], v14 offset:0
    s_add_u32 m0, s4, 0
    s_nop 0
    buffer_load_dwordx4 v8, s[8:11], s24 offen lds
    s_add_u32 m0, s4, 4096
    s_add_u32 s91, s24, 65536
    buffer_load_dwordx4 v8, s[8:11], s91 offen lds
    s_add_u32 m0, s4, 8192
    s_add_u32 s91, s24, 131072
    buffer_load_dwordx4 v8, s[8:11], s91 offen lds
    s_add_u32 m0, s4, 12288
    s_add_u32 s91, s24, 196608
    buffer_load_dwordx4 v8, s[8:11], s91 offen lds
    s_add_u32 m0, s4, 16384
    s_nop 0
    buffer_load_dwordx4 v9, s[16:19], s26 offen lds
    s_add_u32 m0, s4, 20480
    s_add_u32 s91, s26, 65536
    buffer_load_dwordx4 v9, s[16:19], s91 offen lds
    s_add_u32 s24, s24, 262144
    s_add_u32 s26, s26, 128
    ds_read_b64_tr_b16 v[100:101], v12 offset:4096
    ds_read_b64_tr_b16 v[102:103], v12 offset:5120
    ds_read_b64_tr_b16 v[104:105], v13 offset:4096
    ds_read_b64_tr_b16 v[106:107], v13 offset:5120
    ds_read_b128 v[108:111], v15 offset:0
    s_waitcnt lgkmcnt(5)
    v_mfma_f32_32x32x16_bf16 v[24:39], v[88:91], v[96:99], v[24:39]
    v_mfma_f32_32x32x16_bf16 v[40:55], v[92:95], v[96:99], v[40:55]
    ds_read_b64_tr_b16 v[88:89], v12 offset:8192
    ds_read_b64_tr_b16 v[90:91], v12 offset:9216
    ds_read_b64_tr_b16 v[92:93], v13 offset:8192
    ds_read_b64_tr_b16 v[94:95], v13 offset:9216
    ds_read_b128 v[96:99], v16 offset:0
    s_waitcnt lgkmcnt(5)
    v_mfma_f32_32x32x16_bf16 v[24:39], v[100:103], v[108:111], v[24:39]
    v_mfma_f32_32x32x16_bf16 v[40:55], v[104:107], v[108:111], v[40:55]
    ds_read_b64_tr_b16 v[100:101], v12 offset:12288
    ds_read_b64_tr_b16 v[102:103], v12 offset:13312
    ds_read_b64_tr_b16 v[104:105], v13 offset:12288
    ds_read_b64_tr_b16 v[106:107], v13 offset:13312
    ds_read_b128 v[108:111], v17 offset:0
    s_waitcnt lgkmcnt(5)
    v_mfma_f32_32x32x16_bf16 v[24:39], v[88:91], v[96:99], v[24:39]
    v_mfma_f32_32x32x16_bf16 v[40:55], v[92:95], v[96:99], v[40:55]
    s_waitcnt lgkmcnt(0)
    v_mfma_f32_32x32x16_bf16 v[24:39], v[100:103], v[108:111], v[24:39]
    v_mfma_f32_32x32x16_bf16 v[40:55], v[104:107], v[108:111], v[40:55]
    s_waitcnt vmcnt(12)
    s_barrier
    v_add_u32 v12, 24576, v12
    v_add_u32 v13, 24576, v13
    v_add_u32 v14, 24576, v14
    v_add_u32 v15, 24576, v15
    v_add_u32 v16, 24576, v16
    v_add_u32 v17, 24576, v17
    v_add_u32 v18, 24576, v18
    v_add_u32 v19, 24576, v19
    v_add_u32 v20, 24576, v20
    v_add_u32 v21, 24576, v21
    v_add_u32 v22, 24576, v22
    ds_read_b64_tr_b16 v[88:89], v12 offset:0
    ds_read_b64_tr_b16 v[90:91], v12 offset:1024
    ds_read_b64_tr_b16 v[92:93], v13 offset:0
    ds_read_b64_tr_b16 v[94:95], v13 offset:1024
    ds_read_b128 v[96:99], v14 offset:0
    s_add_u32 m0, s4, 24576
    s_nop 0
    buffer_load_dwordx4 v8, s[8:11], s24 offen lds
    s_add_u32 m0, s4, 28672
    s_add_u32 s91, s24, 65536
    buffer_load_dwordx4 v8, s[8:11], s91 offen lds
    s_add_u32 m0, s4, 32768
    s_add_u32 s91, s24, 131072
    buffer_load_dwordx4 v8, s[8:11], s91 offen lds
    s_add_u32 m0, s4, 36864
    s_add_u32 s91, s24, 196608
    buffer_load_dwordx4 v8, s[8:11], s91 offen lds
    s_add_u32 m0, s4, 40960
    s_nop 0
    buffer_load_dwordx4 v9, s[16:19], s26 offen lds
    s_add_u32 m0, s4, 45056
    s_add_u32 s91, s26, 65536
    buffer_load_dwordx4 v9, s[16:19], s91 offen lds
    s_add_u32 s24, s24, 262144
    s_add_u32 s26, s26, 128
    ds_read_b64_tr_b16 v[100:101], v12 offset:4096
    ds_read_b64_tr_b16 v[102:103], v12 offset:5120
    ds_read_b64_tr_b16 v[104:105], v13 offset:4096
    ds_read_b64_tr_b16 v[106:107], v13 offset:5120
    ds_read_b128 v[108:111], v15 offset:0
    s_waitcnt lgkmcnt(5)
    v_mfma_f32_32x32x16_bf16 v[24:39], v[88:91], v[96:99], v[24:39]
    v_mfma_f32_32x32x16_bf16 v[40:55], v[92:95], v[96:99], v[40:55]
    ds_read_b64_tr_b16 v[88:89], v12 offset:8192
    ds_read_b64_tr_b16 v[90:91], v12 offset:9216
    ds_read_b64_tr_b16 v[92:93], v13 offset:8192
    ds_read_b64_tr_b16 v[94:95], v13 offset:9216
    ds_read_b128 v[96:99], v16 offset:0
    s_waitcnt lgkmcnt(5)
    v_mfma_f32_32x32x16_bf16 v[24:39], v[100:103], v[108:111], v[24:39]
    v_mfma_f32_32x32x16_bf16 v[40:55], v[104:107], v[108:111], v[40:55]
    ds_read_b64_tr_b16 v[100:101], v12 offset:12288
    ds_read_b64_tr_b16 v[102:103], v12 offset:13312
    ds_read_b64_tr_b16 v[104:105], v13 offset:12288
    ds_read_b64_tr_b16 v[106:107], v13 offset:13312
    ds_read_b128 v[108:111], v17 offset:0
    s_waitcnt lgkmcnt(5)
    v_mfma_f32_32x32x16_bf16 v[24:39], v[88:91], v[96:99], v[24:39]
    v_mfma_f32_32x32x16_bf16 v[40:55], v[92:95], v[96:99], v[40:55]
    s_waitcnt lgkmcnt(0)
    v_mfma_f32_32x32x16_bf16 v[24:39], v[100:103], v[108:111], v[24:39]
    v_mfma_f32_32x32x16_bf16 v[40:55], v[104:107], v[108:111], v[40:55]
    s_waitcnt vmcnt(12)
    s_barrier
    v_add_u32 v12, 24576, v12
    v_add_u32 v13, 24576, v13
    v_add_u32 v14, 24576, v14
    v_add_u32 v15, 24576, v15
    v_add_u32 v16, 24576, v16
    v_add_u32 v17, 24576, v17
    v_add_u32 v18, 24576, v18
    v_add_u32 v19, 24576, v19
    v_add_u32 v20, 24576, v20
    v_add_u32 v21, 24576, v21
    v_add_u32 v22, 24576, v22
    ds_read_b64_tr_b16 v[88:89], v12 offset:0
    ds_read_b64_tr_b16 v[90:91], v12 offset:1024
    ds_read_b64_tr_b16 v[92:93], v13 offset:0
    ds_read_b64_tr_b16 v[94:95], v13 offset:1024
    ds_read_b128 v[96:99], v14 offset:0
    s_add_u32 m0, s4, 49152
    s_nop 0
    buffer_load_dwordx4 v8, s[8:11], s24 offen lds
    s_add_u32 m0, s4, 53248
    s_add_u32 s91, s24, 65536
    buffer_load_dwordx4 v8, s[8:11], s91 offen lds
    s_add_u32 m0, s4, 57344
    s_add_u32 s91, s24, 131072
    buffer_load_dwordx4 v8, s[8:11], s91 offen lds
    s_add_u32 m0, s4, 61440
    s_add_u32 s91, s24, 196608
    buffer_load_dwordx4 v8, s[8:11], s91 offen lds
    s_add_u32 m0, s4, 65536
    s_nop 0
    buffer_load_dwordx4 v9, s[16:19], s26 offen lds
    s_add_u32 m0, s4, 69632
    s_add_u32 s91, s26, 65536
    buffer_load_dwordx4 v9, s[16:19], s91 offen lds
    s_add_u32 s24, s24, 262144
    s_add_u32 s26, s26, 128
    ds_read_b64_tr_b16 v[100:101], v12 offset:4096
    ds_read_b64_tr_b16 v[102:103], v12 offset:5120
    ds_read_b64_tr_b16 v[104:105], v13 offset:4096
    ds_read_b64_tr_b16 v[106:107], v13 offset:5120
    ds_read_b128 v[108:111], v15 offset:0
    s_waitcnt lgkmcnt(5)
    v_mfma_f32_32x32x16_bf16 v[24:39], v[88:91], v[96:99], v[24:39]
    v_mfma_f32_32x32x16_bf16 v[40:55], v[92:95], v[96:99], v[40:55]
    ds_read_b64_tr_b16 v[88:89], v12 offset:8192
    ds_read_b64_tr_b16 v[90:91], v12 offset:9216
    ds_read_b64_tr_b16 v[92:93], v13 offset:8192
    ds_read_b64_tr_b16 v[94:95], v13 offset:9216
    ds_read_b128 v[96:99], v16 offset:0
    s_waitcnt lgkmcnt(5)
    v_mfma_f32_32x32x16_bf16 v[24:39], v[100:103], v[108:111], v[24:39]
    v_mfma_f32_32x32x16_bf16 v[40:55], v[104:107], v[108:111], v[40:55]
    ds_read_b64_tr_b16 v[100:101], v12 offset:12288
    ds_read_b64_tr_b16 v[102:103], v12 offset:13312
    ds_read_b64_tr_b16 v[104:105], v13 offset:12288
    ds_read_b64_tr_b16 v[106:107], v13 offset:13312
    ds_read_b128 v[108:111], v17 offset:0
    s_waitcnt lgkmcnt(5)
    v_mfma_f32_32x32x16_bf16 v[24:39], v[88:91], v[96:99], v[24:39]
    v_mfma_f32_32x32x16_bf16 v[40:55], v[92:95], v[96:99], v[40:55]
    s_waitcnt lgkmcnt(0)
    v_mfma_f32_32x32x16_bf16 v[24:39], v[100:103], v[108:111], v[24:39]
    v_mfma_f32_32x32x16_bf16 v[40:55], v[104:107], v[108:111], v[40:55]
    s_mov_b32 s92, 3
    v_subrev_u32 v12, 73728, v12
    v_subrev_u32 v13, 73728, v13
    v_subrev_u32 v14, 73728, v14
    v_subrev_u32 v15, 73728, v15
    v_subrev_u32 v16, 73728, v16
    v_subrev_u32 v17, 73728, v17
    v_subrev_u32 v18, 73728, v18
    v_subrev_u32 v19, 73728, v19
    v_subrev_u32 v20, 73728, v20
    v_subrev_u32 v21, 73728, v21
    v_subrev_u32 v22, 73728, v22
L_k_4:
    s_waitcnt vmcnt(12)
    s_barrier
    ds_read_b64_tr_b16 v[88:89], v12 offset:0
    ds_read_b64_tr_b16 v[90:91], v12 offset:1024
    ds_read_b64_tr_b16 v[92:93], v13 offset:0
    ds_read_b64_tr_b16 v[94:95], v13 offset:1024
    ds_read_b128 v[96:99], v14 offset:0
    s_add_u32 m0, s4, 73728
    s_nop 0
    buffer_load_dwordx4 v8, s[8:11], s24 offen lds
    s_add_u32 m0, s4, 77824
    s_add_u32 s91, s24, 65536
    buffer_load_dwordx4 v8, s[8:11], s91 offen lds
    s_add_u32 m0, s4, 81920
    s_add_u32 s91, s24, 131072
    buffer_load_dwordx4 v8, s[8:11], s91 offen lds
    s_add_u32 m0, s4, 86016
    s_add_u32 s91, s24, 196608
    buffer_load_dwordx4 v8, s[8:11], s91 offen lds
    s_add_u32 m0, s4, 90112
    s_nop 0
    buffer_load_dwordx4 v9, s[16:19], s26 offen lds
    s_add_u32 m0, s4, 94208
    s_add_u32 s91, s26, 65536
    buffer_load_dwordx4 v9, s[16:19], s91 offen lds
    s_add_u32 s24, s24, 262144
    s_add_u32 s26, s26, 128
    ds_read_b64_tr_b16 v[100:101], v12 offset:4096
    ds_read_b64_tr_b16 v[102:103], v12 offset:5120
    ds_read_b64_tr_b16 v[104:105], v13 offset:4096
    ds_read_b64_tr_b16 v[106:107], v13 offset:5120
    ds_read_b128 v[108:111], v15 offset:0
    s_waitcnt lgkmcnt(5)
    v_mfma_f32_32x32x16_bf16 v[24:39], v[88:91], v[96:99], v[24:39]
    v_mfma_f32_32x32x16_bf16 v[40:55], v[92:95], v[96:99], v[40:55]
    ds_read_b64_tr_b16 v[88:89], v12 offset:8192
    ds_read_b64_tr_b16 v[90:91], v12 offset:9216
    ds_read_b64_tr_b16 v[92:93], v13 offset:8192
    ds_read_b64_tr_b16 v[94:95], v13 offset:9216
    ds_read_b128 v[96:99], v16 offset:0
    s_waitcnt lgkmcnt(5)
    v_mfma_f32_32x32x16_bf16 v[24:39], v[100:103], v[108:111], v[24:39]
    v_mfma_f32_32x32x16_bf16 v[40:55], v[104:107], v[108:111], v[40:55]
    ds_read_b64_tr_b16 v[100:101], v12 offset:12288
    ds_read_b64_tr_b16 v[102:103], v12 offset:13312
    ds_read_b64_tr_b16 v[104:105], v13 offset:12288
    ds_read_b64_tr_b16 v[106:107], v13 offset:13312
    ds_read_b128 v[108:111], v17 offset:0
    s_waitcnt lgkmcnt(5)
    v_mfma_f32_32x32x16_bf16 v[24:39], v[88:91], v[96:99], v[24:39]
    v_mfma_f32_32x32x16_bf16 v[40:55], v[92:95], v[96:99], v[40:55]
    s_waitcnt lgkmcnt(0)
    v_mfma_f32_32x32x16_bf16 v[24:39], v[100:103], v[108:111], v[24:39]
    v_mfma_f32_32x32x16_bf16 v[40:55], v[104:107], v[108:111], v[40:55]
    s_waitcnt vmcnt(12)
    s_barrier
    v_add_u32 v12, 24576, v12
    v_add_u32 v13, 24576, v13
    v_add_u32 v14, 24576, v14
    v_add_u32 v15, 24576, v15
    v_add_u32 v16, 24576, v16
    v_add_u32 v17, 24576, v17
    v_add_u32 v18, 24576, v18
    v_add_u32 v19, 24576, v19
    v_add_u32 v20, 24576, v20
    v_add_u32 v21, 24576, v21
    v_add_u32 v22, 24576, v22
    ds_read_b64_tr_b16 v[88:89], v12 offset:0
    ds_read_b64_tr_b16 v[90:91], v12 offset:1024
    ds_read_b64_tr_b16 v[92:93], v13 offset:0
    ds_read_b64_tr_b16 v[94:95], v13 offset:1024
    ds_read_b128 v[96:99], v14 offset:0
    s_add_u32 m0, s4, 0
    s_nop 0
    buffer_load_dwordx4 v8, s[8:11], s24 offen lds
    s_add_u32 m0, s4, 4096
    s_add_u32 s91, s24, 65536
    buffer_load_dwordx4 v8, s[8:11], s91 offen lds
    s_add_u32 m0, s4, 8192
    s_add_u32 s91, s24, 131072
    buffer_load_dwordx4 v8, s[8:11], s91 offen lds
    s_add_u32 m0, s4, 12288
    s_add_u32 s91, s24, 196608
    buffer_load_dwordx4 v8, s[8:11], s91 offen lds
    s_add_u32 m0, s4, 16384
    s_nop 0
    buffer_load_dwordx4 v9, s[16:19], s26 offen lds
    s_add_u32 m0, s4, 20480
    s_add_u32 s91, s26, 65536
    buffer_load_dwordx4 v9, s[16:19], s91 offen lds
    s_add_u32 s24, s24, 262144
    s_add_u32 s26, s26, 128
    ds_read_b64_tr_b16 v[100:101], v12 offset:4096
    ds_read_b64_tr_b16 v[102:103], v12 offset:5120
    ds_read_b64_tr_b16 v[104:105], v13 offset:4096
    ds_read_b64_tr_b16 v[106:107], v13 offset:5120
    ds_read_b128 v[108:111], v15 offset:0
    s_waitcnt lgkmcnt(5)
    v_mfma_f32_32x32x16_bf16 v[24:39], v[88:91], v[96:99], v[24:39]
    v_mfma_f32_32x32x16_bf16 v[40:55], v[92:95], v[96:99], v[40:55]
    ds_read_b64_tr_b16 v[88:89], v12 offset:8192
    ds_read_b64_tr_b16 v[90:91], v12 offset:9216
    ds_read_b64_tr_b16 v[92:93], v13 offset:8192
    ds_read_b64_tr_b16 v[94:95], v13 offset:9216
    ds_read_b128 v[96:99], v16 offset:0
    s_waitcnt lgkmcnt(5)
    v_mfma_f32_32x32x16_bf16 v[24:39], v[100:103], v[108:111], v[24:39]
    v_mfma_f32_32x32x16_bf16 v[40:55], v[104:107], v[108:111], v[40:55]
    ds_read_b64_tr_b16 v[100:101], v12 offset:12288
    ds_read_b64_tr_b16 v[102:103], v12 offset:13312
    ds_read_b64_tr_b16 v[104:105], v13 offset:12288
    ds_read_b64_tr_b16 v[106:107], v13 offset:13312
    ds_read_b128 v[108:111], v17 offset:0
    s_waitcnt lgkmcnt(5)
    v_mfma_f32_32x32x16_bf16 v[24:39], v[88:91], v[96:99], v[24:39]
    v_mfma_f32_32x32x16_bf16 v[40:55], v[92:95], v[96:99], v[40:55]
    s_waitcnt lgkmcnt(0)
    v_mfma_f32_32x32x16_bf16 v[24:39], v[100:103], v[108:111], v[24:39]
    v_mfma_f32_32x32x16_bf16 v[40:55], v[104:107], v[108:111], v[40:55]
    s_waitcnt vmcnt(12)
    s_barrier
    v_add_u32 v12, 24576, v12
    v_add_u32 v13, 24576, v13
    v_add_u32 v14, 24576, v14
    v_add_u32 v15, 24576, v15
    v_add_u32 v16, 24576, v16
    v_add_u32 v17, 24576, v17
    v_add_u32 v18, 24576, v18
    v_add_u32 v19, 24576, v19
    v_add_u32 v20, 24576, v20
    v_add_u32 v21, 24576, v21
    v_add_u32 v22, 24576, v22
    ds_read_b64_tr_b16 v[88:89], v12 offset:0
    ds_read_b64_tr_b16 v[90:91], v12 offset:1024
    ds_read_b64_tr_b16 v[92:93], v13 offset:0
    ds_read_b64_tr_b16 v[94:95], v13 offset:1024
    ds_read_b128 v[96:99], v14 offset:0
    s_add_u32 m0, s4, 24576
    s_nop 0
    buffer_load_dwordx4 v8, s[8:11], s24 offen lds
    s_add_u32 m0, s4, 28672
    s_add_u32 s91, s24, 65536
    buffer_load_dwordx4 v8, s[8:11], s91 offen lds
    s_add_u32 m0, s4, 32768
    s_add_u32 s91, s24, 131072
    buffer_load_dwordx4 v8, s[8:11], s91 offen lds
    s_add_u32 m0, s4, 36864
    s_add_u32 s91, s24, 196608
    buffer_load_dwordx4 v8, s[8:11], s91 offen lds
    s_add_u32 m0, s4, 40960
    s_nop 0
    buffer_load_dwordx4 v9, s[16:19], s26 offen lds
    s_add_u32 m0, s4, 45056
    s_add_u32 s91, s26, 65536
    buffer_load_dwordx4 v9, s[16:19], s91 offen lds
    s_add_u32 s24, s24, 262144
    s_add_u32 s26, s26, 128
    ds_read_b64_tr_b16 v[100:101], v12 offset:4096
    ds_read_b64_tr_b16 v[102:103], v12 offset:5120
    ds_read_b64_tr_b16 v[104:105], v13 offset:4096
    ds_read_b64_tr_b16 v[106:107], v13 offset:5120
    ds_read_b128 v[108:111], v15 offset:0
    s_waitcnt lgkmcnt(5)
    v_mfma_f32_32x32x16_bf16 v[24:39], v[88:91], v[96:99], v[24:39]
    v_mfma_f32_32x32x16_bf16 v[40:55], v[92:95], v[96:99], v[40:55]
    ds_read_b64_tr_b16 v[88:89], v12 offset:8192
    ds_read_b64_tr_b16 v[90:91], v12 offset:9216
    ds_read_b64_tr_b16 v[92:93], v13 offset:8192
    ds_read_b64_tr_b16 v[94:95], v13 offset:9216
    ds_read_b128 v[96:99], v16 offset:0
    s_waitcnt lgkmcnt(5)
    v_mfma_f32_32x32x16_bf16 v[24:39], v[100:103], v[108:111], v[24:39]
    v_mfma_f32_32x32x16_bf16 v[40:55], v[104:107], v[108:111], v[40:55]
    ds_read_b64_tr_b16 v[100:101], v12 offset:12288
    ds_read_b64_tr_b16 v[102:103], v12 offset:13312
    ds_read_b64_tr_b16 v[104:105], v13 offset:12288
    ds_read_b64_tr_b16 v[106:107], v13 offset:13312
    ds_read_b128 v[108:111], v17 offset:0
    s_waitcnt lgkmcnt(5)
    v_mfma_f32_32x32x16_bf16 v[24:39], v[88:91], v[96:99], v[24:39]
    v_mfma_f32_32x32x16_bf16 v[40:55], v[92:95], v[96:99], v[40:55]
    s_waitcnt lgkmcnt(0)
    v_mfma_f32_32x32x16_bf16 v[24:39], v[100:103], v[108:111], v[24:39]
    v_mfma_f32_32x32x16_bf16 v[40:55], v[104:107], v[108:111], v[40:55]
    s_waitcnt vmcnt(12)
    s_barrier
    v_add_u32 v12, 24576, v12
    v_add_u32 v13, 24576, v13
    v_add_u32 v14, 24576, v14
    v_add_u32 v15, 24576, v15
    v_add_u32 v16, 24576, v16
    v_add_u32 v17, 24576, v17
    v_add_u32 v18, 24576, v18
    v_add_u32 v19, 24576, v19
    v_add_u32 v20, 24576, v20
    v_add_u32 v21, 24576, v21
    v_add_u32 v22, 24576, v22
    ds_read_b64_tr_b16 v[88:89], v12 offset:0
    ds_read_b64_tr_b16 v[90:91], v12 offset:1024
    ds_read_b64_tr_b16 v[92:93], v13 offset:0
    ds_read_b64_tr_b16 v[94:95], v13 offset:1024
    ds_read_b128 v[96:99], v14 offset:0
    s_add_u32 m0, s4, 49152
    s_nop 0
    buffer_load_dwordx4 v8, s[8:11], s24 offen lds
    s_add_u32 m0, s4, 53248
    s_add_u32 s91, s24, 65536
    buffer_load_dwordx4 v8, s[8:11], s91 offen lds
    s_add_u32 m0, s4, 57344
    s_add_u32 s91, s24, 131072
    buffer_load_dwordx4 v8, s[8:11], s91 offen lds
    s_add_u32 m0, s4, 61440
    s_add_u32 s91, s24, 196608
    buffer_load_dwordx4 v8, s[8:11], s91 offen lds
    s_add_u32 m0, s4, 65536
    s_nop 0
    buffer_load_dwordx4 v9, s[16:19], s26 offen lds
    s_add_u32 m0, s4, 69632
    s_add_u32 s91, s26, 65536
    buffer_load_dwordx4 v9, s[16:19], s91 offen lds
    s_add_u32 s24, s24, 262144
    s_add_u32 s26, s26, 128
    ds_read_b64_tr_b16 v[100:101], v12 offset:4096
    ds_read_b64_tr_b16 v[102:103], v12 offset:5120
    ds_read_b64_tr_b16 v[104:105], v13 offset:4096
    ds_read_b64_tr_b16 v[106:107], v13 offset:5120
    ds_read_b128 v[108:111], v15 offset:0
    s_waitcnt lgkmcnt(5)
    v_mfma_f32_32x32x16_bf16 v[24:39], v[88:91], v[96:99], v[24:39]
    v_mfma_f32_32x32x16_bf16 v[40:55], v[92:95], v[96:99], v[40:55]
    ds_read_b64_tr_b16 v[88:89], v12 offset:8192
    ds_read_b64_tr_b16 v[90:91], v12 offset:9216
    ds_read_b64_tr_b16 v[92:93], v13 offset:8192
    ds_read_b64_tr_b16 v[94:95], v13 offset:9216
    ds_read_b128 v[96:99], v16 offset:0
    s_waitcnt lgkmcnt(5)
    v_mfma_f32_32x32x16_bf16 v[24:39], v[100:103], v[108:111], v[24:39]
    v_mfma_f32_32x32x16_bf16 v[40:55], v[104:107], v[108:111], v[40:55]
    ds_read_b64_tr_b16 v[100:101], v12 offset:12288
    ds_read_b64_tr_b16 v[102:103], v12 offset:13312
    ds_read_b64_tr_b16 v[104:105], v13 offset:12288
    ds_read_b64_tr_b16 v[106:107], v13 offset:13312
    ds_read_b128 v[108:111], v17 offset:0
    s_waitcnt lgkmcnt(5)
    v_mfma_f32_32x32x16_bf16 v[24:39], v[88:91], v[96:99], v[24:39]
    v_mfma_f32_32x32x16_bf16 v[40:55], v[92:95], v[96:99], v[40:55]
    s_waitcnt lgkmcnt(0)
    v_mfma_f32_32x32x16_bf16 v[24:39], v[100:103], v[108:111], v[24:39]
    v_mfma_f32_32x32x16_bf16 v[40:55], v[104:107], v[108:111], v[40:55]
    v_subrev_u32 v12, 73728, v12
    v_subrev_u32 v13, 73728, v13
    v_subrev_u32 v14, 73728, v14
    v_subrev_u32 v15, 73728, v15
    v_subrev_u32 v16, 73728, v16
    v_subrev_u32 v17, 73728, v17
    v_subrev_u32 v18, 73728, v18
    v_subrev_u32 v19, 73728, v19
    v_subrev_u32 v20, 73728, v20
    v_subrev_u32 v21, 73728, v21
    v_subrev_u32 v22, 73728, v22
    s_sub_u32 s92, s92, 1
    s_cmp_lg_u32 s92, 0
    s_cbranch_scc1 L_k_4
    s_waitcnt vmcnt(12)
    s_barrier
    ds_read_b64_tr_b16 v[88:89], v12 offset:0
    ds_read_b64_tr_b16 v[90:91], v12 offset:1024
    ds_read_b64_tr_b16 v[92:93], v13 offset:0
    ds_read_b64_tr_b16 v[94:95], v13 offset:1024
    ds_read_b128 v[96:99], v14 offset:0
    s_add_u32 m0, s4, 73728
    s_nop 0
    buffer_load_dwordx4 v8, s[8:11], s24 offen lds
    s_add_u32 m0, s4, 77824
    s_add_u32 s91, s24, 65536
    buffer_load_dwordx4 v8, s[8:11], s91 offen lds
    s_add_u32 m0, s4, 81920
    s_add_u32 s91, s24, 131072
    buffer_load_dwordx4 v8, s[8:11], s91 offen lds
    s_add_u32 m0, s4, 86016
    s_add_u32 s91, s24, 196608
    buffer_load_dwordx4 v8, s[8:11], s91 offen lds
    s_add_u32 m0, s4, 90112
    s_nop 0
    buffer_load_dwordx4 v9, s[16:19], s26 offen lds
    s_add_u32 m0, s4, 94208
    s_add_u32 s91, s26, 65536
    buffer_load_dwordx4 v9, s[16:19], s91 offen lds
    s_add_u32 s24, s24, 262144
    s_add_u32 s26, s26, 128
    ds_read_b64_tr_b16 v[100:101], v12 offset:4096
    ds_read_b64_tr_b16 v[102:103], v12 offset:5120
    ds_read_b64_tr_b16 v[104:105], v13 offset:4096
    ds_read_b64_tr_b16 v[106:107], v13 offset:5120
    ds_read_b128 v[108:111], v15 offset:0
    s_waitcnt lgkmcnt(5)
    v_mfma_f32_32x32x16_bf16 v[24:39], v[88:91], v[96:99], v[24:39]
    v_mfma_f32_32x32x16_bf16 v[40:55], v[92:95], v[96:99], v[40:55]
    ds_read_b64_tr_b16 v[88:89], v12 offset:8192
    ds_read_b64_tr_b16 v[90:91], v12 offset:9216
    ds_read_b64_tr_b16 v[92:93], v13 offset:8192
    ds_read_b64_tr_b16 v[94:95], v13 offset:9216
    ds_read_b128 v[96:99], v16 offset:0
    s_waitcnt lgkmcnt(5)
    v_mfma_f32_32x32x16_bf16 v[24:39], v[100:103], v[108:111], v[24:39]
    v_mfma_f32_32x32x16_bf16 v[40:55], v[104:107], v[108:111], v[40:55]
    ds_read_b64_tr_b16 v[100:101], v12 offset:12288
    ds_read_b64_tr_b16 v[102:103], v12 offset:13312
    ds_read_b64_tr_b16 v[104:105], v13 offset:12288
    ds_read_b64_tr_b16 v[106:107], v13 offset:13312
    ds_read_b128 v[108:111], v17 offset:0
    s_waitcnt lgkmcnt(5)
    v_mfma_f32_32x32x16_bf16 v[24:39], v[88:91], v[96:99], v[24:39]
    v_mfma_f32_32x32x16_bf16 v[40:55], v[92:95], v[96:99], v[40:55]
    s_waitcnt lgkmcnt(0)
    v_mfma_f32_32x32x16_bf16 v[24:39], v[100:103], v[108:111], v[24:39]
    v_mfma_f32_32x32x16_bf16 v[40:55], v[104:107], v[108:111], v[40:55]
    s_waitcnt vmcnt(12)
    s_barrier
    v_add_u32 v12, 24576, v12
    v_add_u32 v13, 24576, v13
    v_add_u32 v14, 24576, v14
    v_add_u32 v15, 24576, v15
    v_add_u32 v16, 24576, v16
    v_add_u32 v17, 24576, v17
    v_add_u32 v18, 24576, v18
    v_add_u32 v19, 24576, v19
    v_add_u32 v20, 24576, v20
    v_add_u32 v21, 24576, v21
    v_add_u32 v22, 24576, v22
    ds_read_b64_tr_b16 v[88:89], v12 offset:0
    ds_read_b64_tr_b16 v[90:91], v12 offset:1024
    ds_read_b64_tr_b16 v[92:93], v13 offset:0
    ds_read_b64_tr_b16 v[94:95], v13 offset:1024
    ds_read_b128 v[96:99], v14 offset:0
    s_add_u32 m0, s4, 0
    s_nop 0
    buffer_load_dwordx4 v10, s[52:55], s27 offen lds
    s_add_u32 m0, s4, 4096
    s_add_u32 s91, s27, 229376
    buffer_load_dwordx4 v10, s[52:55], s91 offen lds
    s_add_u32 m0, s4, 8192
    s_add_u32 s91, s27, 458752
    buffer_load_dwordx4 v10, s[52:55], s91 offen lds
    s_add_u32 m0, s4, 12288
    s_add_u32 s91, s27, 688128
    buffer_load_dwordx4 v10, s[52:55], s91 offen lds
    s_add_u32 m0, s4, 16384
    s_nop 0
    buffer_load_dwordx4 v11, s[48:51], s38 offen lds
    s_add_u32 m0, s4, 20480
    s_add_u32 s91, s38, 65536
    buffer_load_dwordx4 v11, s[48:51], s91 offen lds
    s_add_u32 s27, s27, 128
    s_add_u32 s38, s38, 131072
    ds_read_b64_tr_b16 v[100:101], v12 offset:4096
    ds_read_b64_tr_b16 v[102:103], v12 offset:5120
    ds_read_b64_tr_b16 v[104:105], v13 offset:4096
    ds_read_b64_tr_b16 v[106:107], v13 offset:5120
    ds_read_b128 v[108:111], v15 offset:0
    s_waitcnt lgkmcnt(5)
    v_mfma_f32_32x32x16_bf16 v[24:39], v[88:91], v[96:99], v[24:39]
    v_mfma_f32_32x32x16_bf16 v[40:55], v[92:95], v[96:99], v[40:55]
    ds_read_b64_tr_b16 v[88:89], v12 offset:8192
    ds_read_b64_tr_b16 v[90:91], v12 offset:9216
    ds_read_b64_tr_b16 v[92:93], v13 offset:8192
    ds_read_b64_tr_b16 v[94:95], v13 offset:9216
    ds_read_b128 v[96:99], v16 offset:0
    s_waitcnt lgkmcnt(5)
    v_mfma_f32_32x32x16_bf16 v[24:39], v[100:103], v[108:111], v[24:39]
    v_mfma_f32_32x32x16_bf16 v[40:55], v[104:107], v[108:111], v[40:55]
    ds_read_b64_tr_b16 v[100:101], v12 offset:12288
    ds_read_b64_tr_b16 v[102:103], v12 offset:13312
    ds_read_b64_tr_b16 v[104:105], v13 offset:12288
    ds_read_b64_tr_b16 v[106:107], v13 offset:13312
    ds_read_b128 v[108:111], v17 offset:0
    s_waitcnt lgkmcnt(5)
    v_mfma_f32_32x32x16_bf16 v[24:39], v[88:91], v[96:99], v[24:39]
    v_mfma_f32_32x32x16_bf16 v[40:55], v[92:95], v[96:99], v[40:55]
    s_waitcnt lgkmcnt(0)
    v_mfma_f32_32x32x16_bf16 v[24:39], v[100:103], v[108:111], v[24:39]
    v_mfma_f32_32x32x16_bf16 v[40:55], v[104:107], v[108:111], v[40:55]
    s_waitcnt vmcnt(12)
    s_barrier
    v_add_u32 v12, 24576, v12
    v_add_u32 v13, 24576, v13
    v_add_u32 v14, 24576, v14
    v_add_u32 v15, 24576, v15
    v_add_u32 v16, 24576, v16
    v_add_u32 v17, 24576, v17
    v_add_u32 v18, 24576, v18
    v_add_u32 v19, 24576, v19
    v_add_u32 v20, 24576, v20
    v_add_u32 v21, 24576, v21
    v_add_u32 v22, 24576, v22
    ds_read_b64_tr_b16 v[88:89], v12 offset:0
    ds_read_b64_tr_b16 v[90:91], v12 offset:1024
    ds_read_b64_tr_b16 v[92:93], v13 offset:0
    ds_read_b64_tr_b16 v[94:95], v13 offset:1024
    ds_read_b128 v[96:99], v14 offset:0
    s_add_u32 m0, s4, 24576
    s_nop 0
    buffer_load_dwordx4 v10, s[52:55], s27 offen lds
    s_add_u32 m0, s4, 28672
    s_add_u32 s91, s27, 229376
    buffer_load_dwordx4 v10, s[52:55], s91 offen lds
    s_add_u32 m0, s4, 32768
    s_add_u32 s91, s27, 458752
    buffer_load_dwordx4 v10, s[52:55], s91 offen lds
    s_add_u32 m0, s4, 36864
    s_add_u32 s91, s27, 688128
    buffer_load_dwordx4 v10, s[52:55], s91 offen lds
    s_add_u32 m0, s4, 40960
    s_nop 0
    buffer_load_dwordx4 v11, s[48:51], s38 offen lds
    s_add_u32 m0, s4, 45056
    s_add_u32 s91, s38, 65536
    buffer_load_dwordx4 v11, s[48:51], s91 offen lds
    s_add_u32 s27, s27, 128
    s_add_u32 s38, s38, 131072
    ds_read_b64_tr_b16 v[100:101], v12 offset:4096
    ds_read_b64_tr_b16 v[102:103], v12 offset:5120
    ds_read_b64_tr_b16 v[104:105], v13 offset:4096
    ds_read_b64_tr_b16 v[106:107], v13 offset:5120
    ds_read_b128 v[108:111], v15 offset:0
    s_waitcnt lgkmcnt(5)
    v_mfma_f32_32x32x16_bf16 v[24:39], v[88:91], v[96:99], v[24:39]
    v_mfma_f32_32x32x16_bf16 v[40:55], v[92:95], v[96:99], v[40:55]
    ds_read_b64_tr_b16 v[88:89], v12 offset:8192
    ds_read_b64_tr_b16 v[90:91], v12 offset:9216
    ds_read_b64_tr_b16 v[92:93], v13 offset:8192
    ds_read_b64_tr_b16 v[94:95], v13 offset:9216
    ds_read_b128 v[96:99], v16 offset:0
    s_waitcnt lgkmcnt(5)
    v_mfma_f32_32x32x16_bf16 v[24:39], v[100:103], v[108:111], v[24:39]
    v_mfma_f32_32x32x16_bf16 v[40:55], v[104:107], v[108:111], v[40:55]
    ds_read_b64_tr_b16 v[100:101], v12 offset:12288
    ds_read_b64_tr_b16 v[102:103], v12 offset:13312
    ds_read_b64_tr_b16 v[104:105], v13 offset:12288
    ds_read_b64_tr_b16 v[106:107], v13 offset:13312
    ds_read_b128 v[108:111], v17 offset:0
    s_waitcnt lgkmcnt(5)
    v_mfma_f32_32x32x16_bf16 v[24:39], v[88:91], v[96:99], v[24:39]
    v_mfma_f32_32x32x16_bf16 v[40:55], v[92:95], v[96:99], v[40:55]
    s_waitcnt lgkmcnt(0)
    v_mfma_f32_32x32x16_bf16 v[24:39], v[100:103], v[108:111], v[24:39]
    v_mfma_f32_32x32x16_bf16 v[40:55], v[104:107], v[108:111], v[40:55]
    s_waitcnt vmcnt(12)
    s_barrier
    v_add_u32 v12, 24576, v12
    v_add_u32 v13, 24576, v13
    v_add_u32 v14, 24576, v14
    v_add_u32 v15, 24576, v15
    v_add_u32 v16, 24576, v16
    v_add_u32 v17, 24576, v17
    v_add_u32 v18, 24576, v18
    v_add_u32 v19, 24576, v19
    v_add_u32 v20, 24576, v20
    v_add_u32 v21, 24576, v21
    v_add_u32 v22, 24576, v22
    ds_read_b64_tr_b16 v[88:89], v12 offset:0
    ds_read_b64_tr_b16 v[90:91], v12 offset:1024
    ds_read_b64_tr_b16 v[92:93], v13 offset:0
    ds_read_b64_tr_b16 v[94:95], v13 offset:1024
    ds_read_b128 v[96:99], v14 offset:0
    s_add_u32 m0, s4, 49152
    s_nop 0
    buffer_load_dwordx4 v10, s[52:55], s27 offen lds
    s_add_u32 m0, s4, 53248
    s_add_u32 s91, s27, 229376
    buffer_load_dwordx4 v10, s[52:55], s91 offen lds
    s_add_u32 m0, s4, 57344
    s_add_u32 s91, s27, 458752
    buffer_load_dwordx4 v10, s[52:55], s91 offen lds
    s_add_u32 m0, s4, 61440
    s_add_u32 s91, s27, 688128
    buffer_load_dwordx4 v10, s[52:55], s91 offen lds
    s_add_u32 m0, s4, 65536
    s_nop 0
    buffer_load_dwordx4 v11, s[48:51], s38 offen lds
    s_add_u32 m0, s4, 69632
    s_add_u32 s91, s38, 65536
    buffer_load_dwordx4 v11, s[48:51], s91 offen lds
    s_add_u32 s27, s27, 128
    s_add_u32 s38, s38, 131072
    ds_read_b64_tr_b16 v[100:101], v12 offset:4096
    ds_read_b64_tr_b16 v[102:103], v12 offset:5120
    ds_read_b64_tr_b16 v[104:105], v13 offset:4096
    ds_read_b64_tr_b16 v[106:107], v13 offset:5120
    ds_read_b128 v[108:111], v15 offset:0
    s_waitcnt lgkmcnt(5)
    v_mfma_f32_32x32x16_bf16 v[24:39], v[88:91], v[96:99], v[24:39]
    v_mfma_f32_32x32x16_bf16 v[40:55], v[92:95], v[96:99], v[40:55]
    ds_read_b64_tr_b16 v[88:89], v12 offset:8192
    ds_read_b64_tr_b16 v[90:91], v12 offset:9216
    ds_read_b64_tr_b16 v[92:93], v13 offset:8192
    ds_read_b64_tr_b16 v[94:95], v13 offset:9216
    ds_read_b128 v[96:99], v16 offset:0
    s_waitcnt lgkmcnt(5)
    v_mfma_f32_32x32x16_bf16 v[24:39], v[100:103], v[108:111], v[24:39]
    v_mfma_f32_32x32x16_bf16 v[40:55], v[104:107], v[108:111], v[40:55]
    ds_read_b64_tr_b16 v[100:101], v12 offset:12288
    ds_read_b64_tr_b16 v[102:103], v12 offset:13312
    ds_read_b64_tr_b16 v[104:105], v13 offset:12288
    ds_read_b64_tr_b16 v[106:107], v13 offset:13312
    ds_read_b128 v[108:111], v17 offset:0
    s_waitcnt lgkmcnt(5)
    v_mfma_f32_32x32x16_bf16 v[24:39], v[88:91], v[96:99], v[24:39]
    v_mfma_f32_32x32x16_bf16 v[40:55], v[92:95], v[96:99], v[40:55]
    s_waitcnt lgkmcnt(0)
    v_mfma_f32_32x32x16_bf16 v[24:39], v[100:103], v[108:111], v[24:39]
    v_mfma_f32_32x32x16_bf16 v[40:55], v[104:107], v[108:111], v[40:55]
    s_mov_b32 s92, 13
    v_subrev_u32 v12, 73728, v12
    v_subrev_u32 v13, 73728, v13
    v_subrev_u32 v14, 73728, v14
    v_subrev_u32 v15, 73728, v15
    v_subrev_u32 v16, 73728, v16
    v_subrev_u32 v17, 73728, v17
    v_subrev_u32 v18, 73728, v18
    v_subrev_u32 v19, 73728, v19
    v_subrev_u32 v20, 73728, v20
    v_subrev_u32 v21, 73728, v21
    v_subrev_u32 v22, 73728, v22
L_k_5:
    s_waitcnt vmcnt(12)
    s_barrier
    ds_read_b128 v[88:91], v18 offset:0
    ds_read_b128 v[92:95], v18 offset:4096
    ds_read_b64_tr_b16 v[96:97], v22 offset:0
    ds_read_b64_tr_b16 v[98:99], v22 offset:512
    s_add_u32 m0, s4, 73728
    s_nop 0
    buffer_load_dwordx4 v10, s[52:55], s27 offen lds
    s_add_u32 m0, s4, 77824
    s_add_u32 s91, s27, 229376
    buffer_load_dwordx4 v10, s[52:55], s91 offen lds
    s_add_u32 m0, s4, 81920
    s_add_u32 s91, s27, 458752
    buffer_load_dwordx4 v10, s[52:55], s91 offen lds
    s_add_u32 m0, s4, 86016
    s_add_u32 s91, s27, 688128
    buffer_load_dwordx4 v10, s[52:55], s91 offen lds
    s_add_u32 m0, s4, 90112
    s_nop 0
    buffer_load_dwordx4 v11, s[48:51], s38 offen lds
    s_add_u32 m0, s4, 94208
    s_add_u32 s91, s38, 65536
    buffer_load_dwordx4 v11, s[48:51], s91 offen lds
    s_add_u32 s27, s27, 128
    s_add_u32 s38, s38, 131072
    ds_read_b128 v[100:103], v19 offset:0
    ds_read_b128 v[104:107], v19 offset:4096
    ds_read_b64_tr_b16 v[108:109], v22 offset:2048
    ds_read_b64_tr_b16 v[110:111], v22 offset:2560
    s_waitcnt lgkmcnt(4)
    v_mfma_f32_32x32x16_bf16 v[56:71], v[88:91], v[96:99], v[56:71]
    v_mfma_f32_32x32x16_bf16 v[72:87], v[92:95], v[96:99], v[72:87]
    ds_read_b128 v[88:91], v20 offset:0
    ds_read_b128 v[92:95], v20 offset:4096
    ds_read_b64_tr_b16 v[96:97], v22 offset:4096
    ds_read_b64_tr_b16 v[98:99], v22 offset:4608
    s_waitcnt lgkmcnt(4)
    v_mfma_f32_32x32x16_bf16 v[56:71], v[100:103], v[108:111], v[56:71]
    v_mfma_f32_32x32x16_bf16 v[72:87], v[104:107], v[108:111], v[72:87]
    ds_read_b128 v[100:103], v21 offset:0
    ds_read_b128 v[104:107], v21 offset:4096
    ds_read_b64_tr_b16 v[108:109], v22 offset:6144
    ds_read_b64_tr_b16 v[110:111], v22 offset:6656
    s_waitcnt lgkmcnt(4)
    v_mfma_f32_32x32x16_bf16 v[56:71], v[88:91], v[96:99], v[56:71]
    v_mfma_f32_32x32x16_bf16 v[72:87], v[92:95], v[96:99], v[72:87]
    s_waitcnt lgkmcnt(0)
    v_mfma_f32_32x32x16_bf16 v[56:71], v[100:103], v[108:111], v[56:71]
    v_mfma_f32_32x32x16_bf16 v[72:87], v[104:107], v[108:111], v[72:87]
    s_waitcnt vmcnt(12)
    s_barrier
    v_add_u32 v12, 24576, v12
    v_add_u32 v13, 24576, v13
    v_add_u32 v14, 24576, v14
    v_add_u32 v15, 24576, v15
    v_add_u32 v16, 24576, v16
    v_add_u32 v17, 24576, v17
    v_add_u32 v18, 24576, v18
    v_add_u32 v19, 24576, v19
    v_add_u32 v20, 24576, v20
    v_add_u32 v21, 24576, v21
    v_add_u32 v22, 24576, v22
    ds_read_b128 v[88:91], v18 offset:0
    ds_read_b128 v[92:95], v18 offset:4096
    ds_read_b64_tr_b16 v[96:97], v22 offset:0
    ds_read_b64_tr_b16 v[98:99], v22 offset:512
    s_add_u32 m0, s4, 0
    s_nop 0
    buffer_load_dwordx4 v10, s[52:55], s27 offen lds
    s_add_u32 m0, s4, 4096
    s_add_u32 s91, s27, 229376
    buffer_load_dwordx4 v10, s[52:55], s91 offen lds
    s_add_u32 m0, s4, 8192
    s_add_u32 s91, s27, 458752
    buffer_load_dwordx4 v10, s[52:55], s91 offen lds
    s_add_u32 m0, s4, 12288
    s_add_u32 s91, s27, 688128
    buffer_load_dwordx4 v10, s[52:55], s91 offen lds
    s_add_u32 m0, s4, 16384
    s_nop 0
    buffer_load_dwordx4 v11, s[48:51], s38 offen lds
    s_add_u32 m0, s4, 20480
    s_add_u32 s91, s38, 65536
    buffer_load_dwordx4 v11, s[48:51], s91 offen lds
    s_add_u32 s27, s27, 128
    s_add_u32 s38, s38, 131072
    ds_read_b128 v[100:103], v19 offset:0
    ds_read_b128 v[104:107], v19 offset:4096
    ds_read_b64_tr_b16 v[108:109], v22 offset:2048
    ds_read_b64_tr_b16 v[110:111], v22 offset:2560
    s_waitcnt lgkmcnt(4)
    v_mfma_f32_32x32x16_bf16 v[56:71], v[88:91], v[96:99], v[56:71]
    v_mfma_f32_32x32x16_bf16 v[72:87], v[92:95], v[96:99], v[72:87]
    ds_read_b128 v[88:91], v20 offset:0
    ds_read_b128 v[92:95], v20 offset:4096
    ds_read_b64_tr_b16 v[96:97], v22 offset:4096
    ds_read_b64_tr_b16 v[98:99], v22 offset:4608
    s_waitcnt lgkmcnt(4)
    v_mfma_f32_32x32x16_bf16 v[56:71], v[100:103], v[108:111], v[56:71]
    v_mfma_f32_32x32x16_bf16 v[72:87], v[104:107], v[108:111], v[72:87]
    ds_read_b128 v[100:103], v21 offset:0
    ds_read_b128 v[104:107], v21 offset:4096
    ds_read_b64_tr_b16 v[108:109], v22 offset:6144
    ds_read_b64_tr_b16 v[110:111], v22 offset:6656
    s_waitcnt lgkmcnt(4)
    v_mfma_f32_32x32x16_bf16 v[56:71], v[88:91], v[96:99], v[56:71]
    v_mfma_f32_32x32x16_bf16 v[72:87], v[92:95], v[96:99], v[72:87]
    s_waitcnt lgkmcnt(0)
    v_mfma_f32_32x32x16_bf16 v[56:71], v[100:103], v[108:111], v[56:71]
    v_mfma_f32_32x32x16_bf16 v[72:87], v[104:107], v[108:111], v[72:87]
    s_waitcnt vmcnt(12)
    s_barrier
    v_add_u32 v12, 24576, v12
    v_add_u32 v13, 24576, v13
    v_add_u32 v14, 24576, v14
    v_add_u32 v15, 24576, v15
    v_add_u32 v16, 24576, v16
    v_add_u32 v17, 24576, v17
    v_add_u32 v18, 24576, v18
    v_add_u32 v19, 24576, v19
    v_add_u32 v20, 24576, v20
    v_add_u32 v21, 24576, v21
    v_add_u32 v22, 24576, v22
    ds_read_b128 v[88:91], v18 offset:0
    ds_read_b128 v[92:95], v18 offset:4096
    ds_read_b64_tr_b16 v[96:97], v22 offset:0
    ds_read_b64_tr_b16 v[98:99], v22 offset:512
    s_add_u32 m0, s4, 24576
    s_nop 0
    buffer_load_dwordx4 v10, s[52:55], s27 offen lds
    s_add_u32 m0, s4, 28672
    s_add_u32 s91, s27, 229376
    buffer_load_dwordx4 v10, s[52:55], s91 offen lds
    s_add_u32 m0, s4, 32768
    s_add_u32 s91, s27, 458752
    buffer_load_dwordx4 v10, s[52:55], s91 offen lds
    s_add_u32 m0, s4, 36864
    s_add_u32 s91, s27, 688128
    buffer_load_dwordx4 v10, s[52:55], s91 offen lds
    s_add_u32 m0, s4, 40960
    s_nop 0
    buffer_load_dwordx4 v11, s[48:51], s38 offen lds
    s_add_u32 m0, s4, 45056
    s_add_u32 s91, s38, 65536
    buffer_load_dwordx4 v11, s[48:51], s91 offen lds
    s_add_u32 s27, s27, 128
    s_add_u32 s38, s38, 131072
    ds_read_b128 v[100:103], v19 offset:0
    ds_read_b128 v[104:107], v19 offset:4096
    ds_read_b64_tr_b16 v[108:109], v22 offset:2048
    ds_read_b64_tr_b16 v[110:111], v22 offset:2560
    s_waitcnt lgkmcnt(4)
    v_mfma_f32_32x32x16_bf16 v[56:71], v[88:91], v[96:99], v[56:71]
    v_mfma_f32_32x32x16_bf16 v[72:87], v[92:95], v[96:99], v[72:87]
    ds_read_b128 v[88:91], v20 offset:0
    ds_read_b128 v[92:95], v20 offset:4096
    ds_read_b64_tr_b16 v[96:97], v22 offset:4096
    ds_read_b64_tr_b16 v[98:99], v22 offset:4608
    s_waitcnt lgkmcnt(4)
    v_mfma_f32_32x32x16_bf16 v[56:71], v[100:103], v[108:111], v[56:71]
    v_mfma_f32_32x32x16_bf16 v[72:87], v[104:107], v[108:111], v[72:87]
    ds_read_b128 v[100:103], v21 offset:0
    ds_read_b128 v[104:107], v21 offset:4096
    ds_read_b64_tr_b16 v[108:109], v22 offset:6144
    ds_read_b64_tr_b16 v[110:111], v22 offset:6656
    s_waitcnt lgkmcnt(4)
    v_mfma_f32_32x32x16_bf16 v[56:71], v[88:91], v[96:99], v[56:71]
    v_mfma_f32_32x32x16_bf16 v[72:87], v[92:95], v[96:99], v[72:87]
    s_waitcnt lgkmcnt(0)
    v_mfma_f32_32x32x16_bf16 v[56:71], v[100:103], v[108:111], v[56:71]
    v_mfma_f32_32x32x16_bf16 v[72:87], v[104:107], v[108:111], v[72:87]
    s_waitcnt vmcnt(12)
    s_barrier
    v_add_u32 v12, 24576, v12
    v_add_u32 v13, 24576, v13
    v_add_u32 v14, 24576, v14
    v_add_u32 v15, 24576, v15
    v_add_u32 v16, 24576, v16
    v_add_u32 v17, 24576, v17
    v_add_u32 v18, 24576, v18
    v_add_u32 v19, 24576, v19
    v_add_u32 v20, 24576, v20
    v_add_u32 v21, 24576, v21
    v_add_u32 v22, 24576, v22
    ds_read_b128 v[88:91], v18 offset:0
    ds_read_b128 v[92:95], v18 offset:4096
    ds_read_b64_tr_b16 v[96:97], v22 offset:0
    ds_read_b64_tr_b16 v[98:99], v22 offset:512
    s_add_u32 m0, s4, 49152
    s_nop 0
    buffer_load_dwordx4 v10, s[52:55], s27 offen lds
    s_add_u32 m0, s4, 53248
    s_add_u32 s91, s27, 229376
    buffer_load_dwordx4 v10, s[52:55], s91 offen lds
    s_add_u32 m0, s4, 57344
    s_add_u32 s91, s27, 458752
    buffer_load_dwordx4 v10, s[52:55], s91 offen lds
    s_add_u32 m0, s4, 61440
    s_add_u32 s91, s27, 688128
    buffer_load_dwordx4 v10, s[52:55], s91 offen lds
    s_add_u32 m0, s4, 65536
    s_nop 0
    buffer_load_dwordx4 v11, s[48:51], s38 offen lds
    s_add_u32 m0, s4, 69632
    s_add_u32 s91, s38, 65536
    buffer_load_dwordx4 v11, s[48:51], s91 offen lds
    s_add_u32 s27, s27, 128
    s_add_u32 s38, s38, 131072
    ds_read_b128 v[100:103], v19 offset:0
    ds_read_b128 v[104:107], v19 offset:4096
    ds_read_b64_tr_b16 v[108:109], v22 offset:2048
    ds_read_b64_tr_b16 v[110:111], v22 offset:2560
    s_waitcnt lgkmcnt(4)
    v_mfma_f32_32x32x16_bf16 v[56:71], v[88:91], v[96:99], v[56:71]
    v_mfma_f32_32x32x16_bf16 v[72:87], v[92:95], v[96:99], v[72:87]
    ds_read_b128 v[88:91], v20 offset:0
    ds_read_b128 v[92:95], v20 offset:4096
    ds_read_b64_tr_b16 v[96:97], v22 offset:4096
    ds_read_b64_tr_b16 v[98:99], v22 offset:4608
    s_waitcnt lgkmcnt(4)
    v_mfma_f32_32x32x16_bf16 v[56:71], v[100:103], v[108:111], v[56:71]
    v_mfma_f32_32x32x16_bf16 v[72:87], v[104:107], v[108:111], v[72:87]
    ds_read_b128 v[100:103], v21 offset:0
    ds_read_b128 v[104:107], v21 offset:4096
    ds_read_b64_tr_b16 v[108:109], v22 offset:6144
    ds_read_b64_tr_b16 v[110:111], v22 offset:6656
    s_waitcnt lgkmcnt(4)
    v_mfma_f32_32x32x16_bf16 v[56:71], v[88:91], v[96:99], v[56:71]
    v_mfma_f32_32x32x16_bf16 v[72:87], v[92:95], v[96:99], v[72:87]
    s_waitcnt lgkmcnt(0)
    v_mfma_f32_32x32x16_bf16 v[56:71], v[100:103], v[108:111], v[56:71]
    v_mfma_f32_32x32x16_bf16 v[72:87], v[104:107], v[108:111], v[72:87]
    v_subrev_u32 v12, 73728, v12
    v_subrev_u32 v13, 73728, v13
    v_subrev_u32 v14, 73728, v14
    v_subrev_u32 v15, 73728, v15
    v_subrev_u32 v16, 73728, v16
    v_subrev_u32 v17, 73728, v17
    v_subrev_u32 v18, 73728, v18
    v_subrev_u32 v19, 73728, v19
    v_subrev_u32 v20, 73728, v20
    v_subrev_u32 v21, 73728, v21
    v_subrev_u32 v22, 73728, v22
    s_sub_u32 s92, s92, 1
    s_cmp_lg_u32 s92, 0
    s_cbranch_scc1 L_k_5
    s_waitcnt vmcnt(12)
    s_barrier
    ds_read_b128 v[88:91], v18 offset:0
    ds_read_b128 v[92:95], v18 offset:4096
    ds_read_b64_tr_b16 v[96:97], v22 offset:0
    ds_read_b64_tr_b16 v[98:99], v22 offset:512
    s_add_u32 m0, s4, 73728
    s_nop 0
    buffer_load_dwordx4 v10, s[52:55], s27 offen lds
    s_add_u32 m0, s4, 77824
    s_add_u32 s91, s27, 229376
    buffer_load_dwordx4 v10, s[52:55], s91 offen lds
    s_add_u32 m0, s4, 81920
    s_add_u32 s91, s27, 458752
    buffer_load_dwordx4 v10, s[52:55], s91 offen lds
    s_add_u32 m0, s4, 86016
    s_add_u32 s91, s27, 688128
    buffer_load_dwordx4 v10, s[52:55], s91 offen lds
    s_add_u32 m0, s4, 90112
    s_nop 0
    buffer_load_dwordx4 v11, s[48:51], s38 offen lds
    s_add_u32 m0, s4, 94208
    s_add_u32 s91, s38, 65536
    buffer_load_dwordx4 v11, s[48:51], s91 offen lds
    s_add_u32 s27, s27, 128
    s_add_u32 s38, s38, 131072
    ds_read_b128 v[100:103], v19 offset:0
    ds_read_b128 v[104:107], v19 offset:4096
    ds_read_b64_tr_b16 v[108:109], v22 offset:2048
    ds_read_b64_tr_b16 v[110:111], v22 offset:2560
    s_waitcnt lgkmcnt(4)
    v_mfma_f32_32x32x16_bf16 v[56:71], v[88:91], v[96:99], v[56:71]
    v_mfma_f32_32x32x16_bf16 v[72:87], v[92:95], v[96:99], v[72:87]
    ds_read_b128 v[88:91], v20 offset:0
    ds_read_b128 v[92:95], v20 offset:4096
    ds_read_b64_tr_b16 v[96:97], v22 offset:4096
    ds_read_b64_tr_b16 v[98:99], v22 offset:4608
    s_waitcnt lgkmcnt(4)
    v_mfma_f32_32x32x16_bf16 v[56:71], v[100:103], v[108:111], v[56:71]
    v_mfma_f32_32x32x16_bf16 v[72:87], v[104:107], v[108:111], v[72:87]
    ds_read_b128 v[100:103], v21 offset:0
    ds_read_b128 v[104:107], v21 offset:4096
    ds_read_b64_tr_b16 v[108:109], v22 offset:6144
    ds_read_b64_tr_b16 v[110:111], v22 offset:6656
    s_waitcnt lgkmcnt(4)
    v_mfma_f32_32x32x16_bf16 v[56:71], v[88:91], v[96:99], v[56:71]
    v_mfma_f32_32x32x16_bf16 v[72:87], v[92:95], v[96:99], v[72:87]
    s_waitcnt lgkmcnt(0)
    v_mfma_f32_32x32x16_bf16 v[56:71], v[100:103], v[108:111], v[56:71]
    v_mfma_f32_32x32x16_bf16 v[72:87], v[104:107], v[108:111], v[72:87]
    s_waitcnt vmcnt(12)
    s_barrier
    v_add_u32 v12, 24576, v12
    v_add_u32 v13, 24576, v13
    v_add_u32 v14, 24576, v14
    v_add_u32 v15, 24576, v15
    v_add_u32 v16, 24576, v16
    v_add_u32 v17, 24576, v17
    v_add_u32 v18, 24576, v18
    v_add_u32 v19, 24576, v19
    v_add_u32 v20, 24576, v20
    v_add_u32 v21, 24576, v21
    v_add_u32 v22, 24576, v22
    ds_read_b128 v[88:91], v18 offset:0
    ds_read_b128 v[92:95], v18 offset:4096
    ds_read_b64_tr_b16 v[96:97], v22 offset:0
    ds_read_b64_tr_b16 v[98:99], v22 offset:512
    ds_read_b128 v[100:103], v19 offset:0
    ds_read_b128 v[104:107], v19 offset:4096
    ds_read_b64_tr_b16 v[108:109], v22 offset:2048
    ds_read_b64_tr_b16 v[110:111], v22 offset:2560
    s_waitcnt lgkmcnt(4)
    v_mfma_f32_32x32x16_bf16 v[56:71], v[88:91], v[96:99], v[56:71]
    v_mfma_f32_32x32x16_bf16 v[72:87], v[92:95], v[96:99], v[72:87]
    ds_read_b128 v[88:91], v20 offset:0
    ds_read_b128 v[92:95], v20 offset:4096
    ds_read_b64_tr_b16 v[96:97], v22 offset:4096
    ds_read_b64_tr_b16 v[98:99], v22 offset:4608
    s_waitcnt lgkmcnt(4)
    v_mfma_f32_32x32x16_bf16 v[56:71], v[100:103], v[108:111], v[56:71]
    v_mfma_f32_32x32x16_bf16 v[72:87], v[104:107], v[108:111], v[72:87]
    ds_read_b128 v[100:103], v21 offset:0
    ds_read_b128 v[104:107], v21 offset:4096
    ds_read_b64_tr_b16 v[108:109], v22 offset:6144
    ds_read_b64_tr_b16 v[110:111], v22 offset:6656
    s_waitcnt lgkmcnt(4)
    v_mfma_f32_32x32x16_bf16 v[56:71], v[88:91], v[96:99], v[56:71]
    v_mfma_f32_32x32x16_bf16 v[72:87], v[92:95], v[96:99], v[72:87]
    s_waitcnt lgkmcnt(0)
    v_mfma_f32_32x32x16_bf16 v[56:71], v[100:103], v[108:111], v[56:71]
    v_mfma_f32_32x32x16_bf16 v[72:87], v[104:107], v[108:111], v[72:87]
    s_waitcnt vmcnt(6)
    s_barrier
    v_add_u32 v12, 24576, v12
    v_add_u32 v13, 24576, v13
    v_add_u32 v14, 24576, v14
    v_add_u32 v15, 24576, v15
    v_add_u32 v16, 24576, v16
    v_add_u32 v17, 24576, v17
    v_add_u32 v18, 24576, v18
    v_add_u32 v19, 24576, v19
    v_add_u32 v20, 24576, v20
    v_add_u32 v21, 24576, v21
    v_add_u32 v22, 24576, v22
    ds_read_b128 v[88:91], v18 offset:0
    ds_read_b128 v[92:95], v18 offset:4096
    ds_read_b64_tr_b16 v[96:97], v22 offset:0
    ds_read_b64_tr_b16 v[98:99], v22 offset:512
    ds_read_b128 v[100:103], v19 offset:0
    ds_read_b128 v[104:107], v19 offset:4096
    ds_read_b64_tr_b16 v[108:109], v22 offset:2048
    ds_read_b64_tr_b16 v[110:111], v22 offset:2560
    s_waitcnt lgkmcnt(4)
    v_mfma_f32_32x32x16_bf16 v[56:71], v[88:91], v[96:99], v[56:71]
    v_mfma_f32_32x32x16_bf16 v[72:87], v[92:95], v[96:99], v[72:87]
    ds_read_b128 v[88:91], v20 offset:0
    ds_read_b128 v[92:95], v20 offset:4096
    ds_read_b64_tr_b16 v[96:97], v22 offset:4096
    ds_read_b64_tr_b16 v[98:99], v22 offset:4608
    s_waitcnt lgkmcnt(4)
    v_mfma_f32_32x32x16_bf16 v[56:71], v[100:103], v[108:111], v[56:71]
    v_mfma_f32_32x32x16_bf16 v[72:87], v[104:107], v[108:111], v[72:87]
    ds_read_b128 v[100:103], v21 offset:0
    ds_read_b128 v[104:107], v21 offset:4096
    ds_read_b64_tr_b16 v[108:109], v22 offset:6144
    ds_read_b64_tr_b16 v[110:111], v22 offset:6656
    s_waitcnt lgkmcnt(4)
    v_mfma_f32_32x32x16_bf16 v[56:71], v[88:91], v[96:99], v[56:71]
    v_mfma_f32_32x32x16_bf16 v[72:87], v[92:95], v[96:99], v[72:87]
    s_waitcnt lgkmcnt(0)
    v_mfma_f32_32x32x16_bf16 v[56:71], v[100:103], v[108:111], v[56:71]
    v_mfma_f32_32x32x16_bf16 v[72:87], v[104:107], v[108:111], v[72:87]
    s_waitcnt vmcnt(0)
    s_barrier
    v_add_u32 v12, 24576, v12
    v_add_u32 v13, 24576, v13
    v_add_u32 v14, 24576, v14
    v_add_u32 v15, 24576, v15
    v_add_u32 v16, 24576, v16
    v_add_u32 v17, 24576, v17
    v_add_u32 v18, 24576, v18
    v_add_u32 v19, 24576, v19
    v_add_u32 v20, 24576, v20
    v_add_u32 v21, 24576, v21
    v_add_u32 v22, 24576, v22
    ds_read_b128 v[88:91], v18 offset:0
    ds_read_b128 v[92:95], v18 offset:4096
    ds_read_b64_tr_b16 v[96:97], v22 offset:0
    ds_read_b64_tr_b16 v[98:99], v22 offset:512
    ds_read_b128 v[100:103], v19 offset:0
    ds_read_b128 v[104:107], v19 offset:4096
    ds_read_b64_tr_b16 v[108:109], v22 offset:2048
    ds_read_b64_tr_b16 v[110:111], v22 offset:2560
    s_waitcnt lgkmcnt(4)
    v_mfma_f32_32x32x16_bf16 v[56:71], v[88:91], v[96:99], v[56:71]
    v_mfma_f32_32x32x16_bf16 v[72:87], v[92:95], v[96:99], v[72:87]
    ds_read_b128 v[88:91], v20 offset:0
    ds_read_b128 v[92:95], v20 offset:4096
    ds_read_b64_tr_b16 v[96:97], v22 offset:4096
    ds_read_b64_tr_b16 v[98:99], v22 offset:4608
    s_waitcnt lgkmcnt(4)
    v_mfma_f32_32x32x16_bf16 v[56:71], v[100:103], v[108:111], v[56:71]
    v_mfma_f32_32x32x16_bf16 v[72:87], v[104:107], v[108:111], v[72:87]
    ds_read_b128 v[100:103], v21 offset:0
    ds_read_b128 v[104:107], v21 offset:4096
    ds_read_b64_tr_b16 v[108:109], v22 offset:6144
    ds_read_b64_tr_b16 v[110:111], v22 offset:6656
    s_waitcnt lgkmcnt(4)
    v_mfma_f32_32x32x16_bf16 v[56:71], v[88:91], v[96:99], v[56:71]
    v_mfma_f32_32x32x16_bf16 v[72:87], v[92:95], v[96:99], v[72:87]
    s_waitcnt lgkmcnt(0)
    v_mfma_f32_32x32x16_bf16 v[56:71], v[100:103], v[108:111], v[56:71]
    v_mfma_f32_32x32x16_bf16 v[72:87], v[104:107], v[108:111], v[72:87]
    v_subrev_u32 v12, 73728, v12
    v_subrev_u32 v13, 73728, v13
    v_subrev_u32 v14, 73728, v14
    v_subrev_u32 v15, 73728, v15
    v_subrev_u32 v16, 73728, v16
    v_subrev_u32 v17, 73728, v17
    v_subrev_u32 v18, 73728, v18
    v_subrev_u32 v19, 73728, v19
    v_subrev_u32 v20, 73728, v20
    v_subrev_u32 v21, 73728, v21
    v_subrev_u32 v22, 73728, v22
    s_load_dwordx2 s[4:5], s[0:1], 0
    s_load_dwordx2 s[6:7], s[0:1], 64
    s_load_dwordx2 s[40:41], s[0:1], 104
    s_waitcnt lgkmcnt(0)
    s_mov_b32 s12, s4
    s_mov_b32 s13, s5
    s_mov_b32 s14, 4194304
    s_mov_b32 s15, 0x00020000
    s_mov_b32 s16, s6
    s_mov_b32 s17, s7
    s_mov_b32 s18, 2048
    s_mov_b32 s19, 0x00020000
    s_mov_b32 s20, s40
    s_mov_b32 s21, s41
    s_mov_b32 s22, 8388608
    s_mov_b32 s23, 0x00020000
    s_mov_b32 s8, s28
    s_mov_b32 s9, s29
    s_mov_b32 s10, 4194304
    s_mov_b32 s11, 0x00020000
    v_and_b32 v112, 31, v1
    v_add_u32 v112, s33, v112
    s_lshl_b32 s34, s31, 6
    v_add_u32 v112, s34, v112
    v_lshlrev_b32 v113, 1, v112
    buffer_load_ushort v114, v113, s[16:19], 0 offen
    v_lshrrev_b32 v113, 5, v1
    v_lshlrev_b32 v113, 2, v113
    v_add_u32 v113, s32, v113
    s_lshl_b32 s34, s30, 7
    v_add_u32 v113, s34, v113
    v_lshl_add_u32 v113, v113, 10, v112
    v_lshlrev_b32 v113, 1, v113
    s_nop 15
    s_mov_b32 s35, 0
    buffer_load_ushort v116, v113, s[12:15], s35 offen
    buffer_load_ushort v132, v113, s[8:11], s35 offen
    s_mov_b32 s35, 2048
    buffer_load_ushort v117, v113, s[12:15], s35 offen
    buffer_load_ushort v133, v113, s[8:11], s35 offen
    s_mov_b32 s35, 4096
    buffer_load_ushort v118, v113, s[12:15], s35 offen
    buffer_load_ushort v134, v113, s[8:11], s35 offen
    s_mov_b32 s35, 6144
    buffer_load_ushort v119, v113, s[12:15], s35 offen
    buffer_load_ushort v135, v113, s[8:11], s35 offen
    s_mov_b32 s35, 16384
    buffer_load_ushort v120, v113, s[12:15], s35 offen
    buffer_load_ushort v136, v113, s[8:11], s35 offen
    s_mov_b32 s35, 18432
    buffer_load_ushort v121, v113, s[12:15], s35 offen
    buffer_load_ushort v137, v113, s[8:11], s35 offen
    s_mov_b32 s35, 20480
    buffer_load_ushort v122, v113, s[12:15], s35 offen
    buffer_load_ushort v138, v113, s[8:11], s35 offen
    s_mov_b32 s35, 22528
    buffer_load_ushort v123, v113, s[12:15], s35 offen
    buffer_load_ushort v139, v113, s[8:11], s35 offen
    s_mov_b32 s35, 32768
    buffer_load_ushort v124, v113, s[12:15], s35 offen
    buffer_load_ushort v140, v113, s[8:11], s35 offen
    s_mov_b32 s35, 34816
    buffer_load_ushort v125, v113, s[12:15], s35 offen
    buffer_load_ushort v141, v113, s[8:11], s35 offen
    s_mov_b32 s35, 36864
    buffer_load_ushort v126, v113, s[12:15], s35 offen
    buffer_load_ushort v142, v113, s[8:11], s35 offen
    s_mov_b32 s35, 38912
    buffer_load_ushort v127, v113, s[12:15], s35 offen
    buffer_load_ushort v143, v113, s[8:11], s35 offen
    s_mov_b32 s35, 49152
    buffer_load_ushort v128, v113, s[12:15], s35 offen
    buffer_load_ushort v144, v113, s[8:11], s35 offen
    s_mov_b32 s35, 51200
    buffer_load_ushort v129, v113, s[12:15], s35 offen
    buffer_load_ushort v145, v113, s[8:11], s35 offen
    s_mov_b32 s35, 53248
    buffer_load_ushort v130, v113, s[12:15], s35 offen
    buffer_load_ushort v146, v113, s[8:11], s35 offen
    s_mov_b32 s35, 55296
    buffer_load_ushort v131, v113, s[12:15], s35 offen
    buffer_load_ushort v147, v113, s[8:11], s35 offen
    s_waitcnt vmcnt(0)
    v_lshlrev_b32 v114, 16, v114
    v_lshlrev_b32 v132, 16, v132
    v_mul_f32 v132, v132, v114
    v_cvt_pk_bf16_f32 v132, v132, v56
    v_and_b32 v148, 0xffff0000, v132
    v_lshlrev_b32 v132, 16, v132
    v_fma_f32 v132, 2.0, v24, v132
    v_mul_f32 v149, 0xbfb8aa3b, v148
    v_exp_f32 v149, v149
    s_nop 0
    v_add_f32 v149, 1.0, v149
    v_rcp_f32 v149, v149
    s_nop 0
    v_mul_f32 v149, v149, v148
    v_cvt_pk_bf16_f32 v149, v149, v149
    v_lshlrev_b32 v149, 16, v149
    v_lshlrev_b32 v116, 16, v116
    v_fma_f32 v116, v132, v149, v116
    v_lshlrev_b32 v133, 16, v133
    v_mul_f32 v133, v133, v114
    v_cvt_pk_bf16_f32 v133, v133, v57
    v_and_b32 v148, 0xffff0000, v133
    v_lshlrev_b32 v133, 16, v133
    v_fma_f32 v133, 2.0, v25, v133
    v_mul_f32 v149, 0xbfb8aa3b, v148
    v_exp_f32 v149, v149
    s_nop 0
    v_add_f32 v149, 1.0, v149
    v_rcp_f32 v149, v149
    s_nop 0
    v_mul_f32 v149, v149, v148
    v_cvt_pk_bf16_f32 v149, v149, v149
    v_lshlrev_b32 v149, 16, v149
    v_lshlrev_b32 v117, 16, v117
    v_fma_f32 v117, v133, v149, v117
    v_lshlrev_b32 v134, 16, v134
    v_mul_f32 v134, v134, v114
    v_cvt_pk_bf16_f32 v134, v134, v58
    v_and_b32 v148, 0xffff0000, v134
    v_lshlrev_b32 v134, 16, v134
    v_fma_f32 v134, 2.0, v26, v134
    v_mul_f32 v149, 0xbfb8aa3b, v148
    v_exp_f32 v149, v149
    s_nop 0
    v_add_f32 v149, 1.0, v149
    v_rcp_f32 v149, v149
    s_nop 0
    v_mul_f32 v149, v149, v148
    v_cvt_pk_bf16_f32 v149, v149, v149
    v_lshlrev_b32 v149, 16, v149
    v_lshlrev_b32 v118, 16, v118
    v_fma_f32 v118, v134, v149, v118
    v_lshlrev_b32 v135, 16, v135
    v_mul_f32 v135, v135, v114
    v_cvt_pk_bf16_f32 v135, v135, v59
    v_and_b32 v148, 0xffff0000, v135
    v_lshlrev_b32 v135, 16, v135
    v_fma_f32 v135, 2.0, v27, v135
    v_mul_f32 v149, 0xbfb8aa3b, v148
    v_exp_f32 v149, v149
    s_nop 0
    v_add_f32 v149, 1.0, v149
    v_rcp_f32 v149, v149
    s_nop 0
    v_mul_f32 v149, v149, v148
    v_cvt_pk_bf16_f32 v149, v149, v149
    v_lshlrev_b32 v149, 16, v149
    v_lshlrev_b32 v119, 16, v119
    v_fma_f32 v119, v135, v149, v119
    v_lshlrev_b32 v136, 16, v136
    v_mul_f32 v136, v136, v114
    v_cvt_pk_bf16_f32 v136, v136, v60
    v_and_b32 v148, 0xffff0000, v136
    v_lshlrev_b32 v136, 16, v136
    v_fma_f32 v136, 2.0, v28, v136
    v_mul_f32 v149, 0xbfb8aa3b, v148
    v_exp_f32 v149, v149
    s_nop 0
    v_add_f32 v149, 1.0, v149
    v_rcp_f32 v149, v149
    s_nop 0
    v_mul_f32 v149, v149, v148
    v_cvt_pk_bf16_f32 v149, v149, v149
    v_lshlrev_b32 v149, 16, v149
    v_lshlrev_b32 v120, 16, v120
    v_fma_f32 v120, v136, v149, v120
    v_lshlrev_b32 v137, 16, v137
    v_mul_f32 v137, v137, v114
    v_cvt_pk_bf16_f32 v137, v137, v61
    v_and_b32 v148, 0xffff0000, v137
    v_lshlrev_b32 v137, 16, v137
    v_fma_f32 v137, 2.0, v29, v137
    v_mul_f32 v149, 0xbfb8aa3b, v148
    v_exp_f32 v149, v149
    s_nop 0
    v_add_f32 v149, 1.0, v149
    v_rcp_f32 v149, v149
    s_nop 0
    v_mul_f32 v149, v149, v148
    v_cvt_pk_bf16_f32 v149, v149, v149
    v_lshlrev_b32 v149, 16, v149
    v_lshlrev_b32 v121, 16, v121
    v_fma_f32 v121, v137, v149, v121
    v_lshlrev_b32 v138, 16, v138
    v_mul_f32 v138, v138, v114
    v_cvt_pk_bf16_f32 v138, v138, v62
    v_and_b32 v148, 0xffff0000, v138
    v_lshlrev_b32 v138, 16, v138
    v_fma_f32 v138, 2.0, v30, v138
    v_mul_f32 v149, 0xbfb8aa3b, v148
    v_exp_f32 v149, v149
    s_nop 0
    v_add_f32 v149, 1.0, v149
    v_rcp_f32 v149, v149
    s_nop 0
    v_mul_f32 v149, v149, v148
    v_cvt_pk_bf16_f32 v149, v149, v149
    v_lshlrev_b32 v149, 16, v149
    v_lshlrev_b32 v122, 16, v122
    v_fma_f32 v122, v138, v149, v122
    v_lshlrev_b32 v139, 16, v139
    v_mul_f32 v139, v139, v114
    v_cvt_pk_bf16_f32 v139, v139, v63
    v_and_b32 v148, 0xffff0000, v139
    v_lshlrev_b32 v139, 16, v139
    v_fma_f32 v139, 2.0, v31, v139
    v_mul_f32 v149, 0xbfb8aa3b, v148
    v_exp_f32 v149, v149
    s_nop 0
    v_add_f32 v149, 1.0, v149
    v_rcp_f32 v149, v149
    s_nop 0
    v_mul_f32 v149, v149, v148
    v_cvt_pk_bf16_f32 v149, v149, v149
    v_lshlrev_b32 v149, 16, v149
    v_lshlrev_b32 v123, 16, v123
    v_fma_f32 v123, v139, v149, v123
    v_lshlrev_b32 v140, 16, v140
    v_mul_f32 v140, v140, v114
    v_cvt_pk_bf16_f32 v140, v140, v64
    v_and_b32 v148, 0xffff0000, v140
    v_lshlrev_b32 v140, 16, v140
    v_fma_f32 v140, 2.0, v32, v140
    v_mul_f32 v149, 0xbfb8aa3b, v148
    v_exp_f32 v149, v149
    s_nop 0
    v_add_f32 v149, 1.0, v149
    v_rcp_f32 v149, v149
    s_nop 0
    v_mul_f32 v149, v149, v148
    v_cvt_pk_bf16_f32 v149, v149, v149
    v_lshlrev_b32 v149, 16, v149
    v_lshlrev_b32 v124, 16, v124
    v_fma_f32 v124, v140, v149, v124
    v_lshlrev_b32 v141, 16, v141
    v_mul_f32 v141, v141, v114
    v_cvt_pk_bf16_f32 v141, v141, v65
    v_and_b32 v148, 0xffff0000, v141
    v_lshlrev_b32 v141, 16, v141
    v_fma_f32 v141, 2.0, v33, v141
    v_mul_f32 v149, 0xbfb8aa3b, v148
    v_exp_f32 v149, v149
    s_nop 0
    v_add_f32 v149, 1.0, v149
    v_rcp_f32 v149, v149
    s_nop 0
    v_mul_f32 v149, v149, v148
    v_cvt_pk_bf16_f32 v149, v149, v149
    v_lshlrev_b32 v149, 16, v149
    v_lshlrev_b32 v125, 16, v125
    v_fma_f32 v125, v141, v149, v125
    v_lshlrev_b32 v142, 16, v142
    v_mul_f32 v142, v142, v114
    v_cvt_pk_bf16_f32 v142, v142, v66
    v_and_b32 v148, 0xffff0000, v142
    v_lshlrev_b32 v142, 16, v142
    v_fma_f32 v142, 2.0, v34, v142
    v_mul_f32 v149, 0xbfb8aa3b, v148
    v_exp_f32 v149, v149
    s_nop 0
    v_add_f32 v149, 1.0, v149
    v_rcp_f32 v149, v149
    s_nop 0
    v_mul_f32 v149, v149, v148
    v_cvt_pk_bf16_f32 v149, v149, v149
    v_lshlrev_b32 v149, 16, v149
    v_lshlrev_b32 v126, 16, v126
    v_fma_f32 v126, v142, v149, v126
    v_lshlrev_b32 v143, 16, v143
    v_mul_f32 v143, v143, v114
    v_cvt_pk_bf16_f32 v143, v143, v67
    v_and_b32 v148, 0xffff0000, v143
    v_lshlrev_b32 v143, 16, v143
    v_fma_f32 v143, 2.0, v35, v143
    v_mul_f32 v149, 0xbfb8aa3b, v148
    v_exp_f32 v149, v149
    s_nop 0
    v_add_f32 v149, 1.0, v149
    v_rcp_f32 v149, v149
    s_nop 0
    v_mul_f32 v149, v149, v148
    v_cvt_pk_bf16_f32 v149, v149, v149
    v_lshlrev_b32 v149, 16, v149
    v_lshlrev_b32 v127, 16, v127
    v_fma_f32 v127, v143, v149, v127
    v_lshlrev_b32 v144, 16, v144
    v_mul_f32 v144, v144, v114
    v_cvt_pk_bf16_f32 v144, v144, v68
    v_and_b32 v148, 0xffff0000, v144
    v_lshlrev_b32 v144, 16, v144
    v_fma_f32 v144, 2.0, v36, v144
    v_mul_f32 v149, 0xbfb8aa3b, v148
    v_exp_f32 v149, v149
    s_nop 0
    v_add_f32 v149, 1.0, v149
    v_rcp_f32 v149, v149
    s_nop 0
    v_mul_f32 v149, v149, v148
    v_cvt_pk_bf16_f32 v149, v149, v149
    v_lshlrev_b32 v149, 16, v149
    v_lshlrev_b32 v128, 16, v128
    v_fma_f32 v128, v144, v149, v128
    v_lshlrev_b32 v145, 16, v145
    v_mul_f32 v145, v145, v114
    v_cvt_pk_bf16_f32 v145, v145, v69
    v_and_b32 v148, 0xffff0000, v145
    v_lshlrev_b32 v145, 16, v145
    v_fma_f32 v145, 2.0, v37, v145
    v_mul_f32 v149, 0xbfb8aa3b, v148
    v_exp_f32 v149, v149
    s_nop 0
    v_add_f32 v149, 1.0, v149
    v_rcp_f32 v149, v149
    s_nop 0
    v_mul_f32 v149, v149, v148
    v_cvt_pk_bf16_f32 v149, v149, v149
    v_lshlrev_b32 v149, 16, v149
    v_lshlrev_b32 v129, 16, v129
    v_fma_f32 v129, v145, v149, v129
    v_lshlrev_b32 v146, 16, v146
    v_mul_f32 v146, v146, v114
    v_cvt_pk_bf16_f32 v146, v146, v70
    v_and_b32 v148, 0xffff0000, v146
    v_lshlrev_b32 v146, 16, v146
    v_fma_f32 v146, 2.0, v38, v146
    v_mul_f32 v149, 0xbfb8aa3b, v148
    v_exp_f32 v149, v149
    s_nop 0
    v_add_f32 v149, 1.0, v149
    v_rcp_f32 v149, v149
    s_nop 0
    v_mul_f32 v149, v149, v148
    v_cvt_pk_bf16_f32 v149, v149, v149
    v_lshlrev_b32 v149, 16, v149
    v_lshlrev_b32 v130, 16, v130
    v_fma_f32 v130, v146, v149, v130
    v_lshlrev_b32 v147, 16, v147
    v_mul_f32 v147, v147, v114
    v_cvt_pk_bf16_f32 v147, v147, v71
    v_and_b32 v148, 0xffff0000, v147
    v_lshlrev_b32 v147, 16, v147
    v_fma_f32 v147, 2.0, v39, v147
    v_mul_f32 v149, 0xbfb8aa3b, v148
    v_exp_f32 v149, v149
    s_nop 0
    v_add_f32 v149, 1.0, v149
    v_rcp_f32 v149, v149
    s_nop 0
    v_mul_f32 v149, v149, v148
    v_cvt_pk_bf16_f32 v149, v149, v149
    v_lshlrev_b32 v149, 16, v149
    v_lshlrev_b32 v131, 16, v131
    v_fma_f32 v131, v147, v149, v131
    v_lshlrev_b32 v150, 1, v113
    s_mov_b32 s35, 0
    buffer_store_dword v116, v150, s[20:23], s35 offen
    s_mov_b32 s35, 4096
    buffer_store_dword v117, v150, s[20:23], s35 offen
    s_mov_b32 s35, 8192
    buffer_store_dword v118, v150, s[20:23], s35 offen
    s_mov_b32 s35, 12288
    buffer_store_dword v119, v150, s[20:23], s35 offen
    s_mov_b32 s35, 32768
    buffer_store_dword v120, v150, s[20:23], s35 offen
    s_mov_b32 s35, 36864
    buffer_store_dword v121, v150, s[20:23], s35 offen
    s_mov_b32 s35, 40960
    buffer_store_dword v122, v150, s[20:23], s35 offen
    s_mov_b32 s35, 45056
    buffer_store_dword v123, v150, s[20:23], s35 offen
    s_mov_b32 s35, 65536
    buffer_store_dword v124, v150, s[20:23], s35 offen
    s_mov_b32 s35, 69632
    buffer_store_dword v125, v150, s[20:23], s35 offen
    s_mov_b32 s35, 73728
    buffer_store_dword v126, v150, s[20:23], s35 offen
    s_mov_b32 s35, 77824
    buffer_store_dword v127, v150, s[20:23], s35 offen
    s_mov_b32 s35, 98304
    buffer_store_dword v128, v150, s[20:23], s35 offen
    s_mov_b32 s35, 102400
    buffer_store_dword v129, v150, s[20:23], s35 offen
    s_mov_b32 s35, 106496
    buffer_store_dword v130, v150, s[20:23], s35 offen
    s_mov_b32 s35, 110592
    buffer_store_dword v131, v150, s[20:23], s35 offen
    s_waitcnt vmcnt(0)
    s_mov_b32 s35, 65536
    buffer_load_ushort v116, v113, s[12:15], s35 offen
    buffer_load_ushort v132, v113, s[8:11], s35 offen
    s_mov_b32 s35, 67584
    buffer_load_ushort v117, v113, s[12:15], s35 offen
    buffer_load_ushort v133, v113, s[8:11], s35 offen
    s_mov_b32 s35, 69632
    buffer_load_ushort v118, v113, s[12:15], s35 offen
    buffer_load_ushort v134, v113, s[8:11], s35 offen
    s_mov_b32 s35, 71680
    buffer_load_ushort v119, v113, s[12:15], s35 offen
    buffer_load_ushort v135, v113, s[8:11], s35 offen
    s_mov_b32 s35, 81920
    buffer_load_ushort v120, v113, s[12:15], s35 offen
    buffer_load_ushort v136, v113, s[8:11], s35 offen
    s_mov_b32 s35, 83968
    buffer_load_ushort v121, v113, s[12:15], s35 offen
    buffer_load_ushort v137, v113, s[8:11], s35 offen
    s_mov_b32 s35, 86016
    buffer_load_ushort v122, v113, s[12:15], s35 offen
    buffer_load_ushort v138, v113, s[8:11], s35 offen
    s_mov_b32 s35, 88064
    buffer_load_ushort v123, v113, s[12:15], s35 offen
    buffer_load_ushort v139, v113, s[8:11], s35 offen
    s_mov_b32 s35, 98304
    buffer_load_ushort v124, v113, s[12:15], s35 offen
    buffer_load_ushort v140, v113, s[8:11], s35 offen
    s_mov_b32 s35, 100352
    buffer_load_ushort v125, v113, s[12:15], s35 offen
    buffer_load_ushort v141, v113, s[8:11], s35 offen
    s_mov_b32 s35, 102400
    buffer_load_ushort v126, v113, s[12:15], s35 offen
    buffer_load_ushort v142, v113, s[8:11], s35 offen
    s_mov_b32 s35, 104448
    buffer_load_ushort v127, v113, s[12:15], s35 offen
    buffer_load_ushort v143, v113, s[8:11], s35 offen
    s_mov_b32 s35, 114688
    buffer_load_ushort v128, v113, s[12:15], s35 offen
    buffer_load_ushort v144, v113, s[8:11], s35 offen
    s_mov_b32 s35, 116736
    buffer_load_ushort v129, v113, s[12:15], s35 offen
    buffer_load_ushort v145, v113, s[8:11], s35 offen
    s_mov_b32 s35, 118784
    buffer_load_ushort v130, v113, s[12:15], s35 offen
    buffer_load_ushort v146, v113, s[8:11], s35 offen
    s_mov_b32 s35, 120832
    buffer_load_ushort v131, v113, s[12:15], s35 offen
    buffer_load_ushort v147, v113, s[8:11], s35 offen
    s_waitcnt vmcnt(0)
    v_lshlrev_b32 v132, 16, v132
    v_mul_f32 v132, v132, v114
    v_cvt_pk_bf16_f32 v132, v132, v72
    v_and_b32 v148, 0xffff0000, v132
    v_lshlrev_b32 v132, 16, v132
    v_fma_f32 v132, 2.0, v40, v132
    v_mul_f32 v149, 0xbfb8aa3b, v148
    v_exp_f32 v149, v149
    s_nop 0
    v_add_f32 v149, 1.0, v149
    v_rcp_f32 v149, v149
    s_nop 0
    v_mul_f32 v149, v149, v148
    v_cvt_pk_bf16_f32 v149, v149, v149
    v_lshlrev_b32 v149, 16, v149
    v_lshlrev_b32 v116, 16, v116
    v_fma_f32 v116, v132, v149, v116
    v_lshlrev_b32 v133, 16, v133
    v_mul_f32 v133, v133, v114
    v_cvt_pk_bf16_f32 v133, v133, v73
    v_and_b32 v148, 0xffff0000, v133
    v_lshlrev_b32 v133, 16, v133
    v_fma_f32 v133, 2.0, v41, v133
    v_mul_f32 v149, 0xbfb8aa3b, v148
    v_exp_f32 v149, v149
    s_nop 0
    v_add_f32 v149, 1.0, v149
    v_rcp_f32 v149, v149
    s_nop 0
    v_mul_f32 v149, v149, v148
    v_cvt_pk_bf16_f32 v149, v149, v149
    v_lshlrev_b32 v149, 16, v149
    v_lshlrev_b32 v117, 16, v117
    v_fma_f32 v117, v133, v149, v117
    v_lshlrev_b32 v134, 16, v134
    v_mul_f32 v134, v134, v114
    v_cvt_pk_bf16_f32 v134, v134, v74
    v_and_b32 v148, 0xffff0000, v134
    v_lshlrev_b32 v134, 16, v134
    v_fma_f32 v134, 2.0, v42, v134
    v_mul_f32 v149, 0xbfb8aa3b, v148
    v_exp_f32 v149, v149
    s_nop 0
    v_add_f32 v149, 1.0, v149
    v_rcp_f32 v149, v149
    s_nop 0
    v_mul_f32 v149, v149, v148
    v_cvt_pk_bf16_f32 v149, v149, v149
    v_lshlrev_b32 v149, 16, v149
    v_lshlrev_b32 v118, 16, v118
    v_fma_f32 v118, v134, v149, v118
    v_lshlrev_b32 v135, 16, v135
    v_mul_f32 v135, v135, v114
    v_cvt_pk_bf16_f32 v135, v135, v75
    v_and_b32 v148, 0xffff0000, v135
    v_lshlrev_b32 v135, 16, v135
    v_fma_f32 v135, 2.0, v43, v135
    v_mul_f32 v149, 0xbfb8aa3b, v148
    v_exp_f32 v149, v149
    s_nop 0
    v_add_f32 v149, 1.0, v149
    v_rcp_f32 v149, v149
    s_nop 0
    v_mul_f32 v149, v149, v148
    v_cvt_pk_bf16_f32 v149, v149, v149
    v_lshlrev_b32 v149, 16, v149
    v_lshlrev_b32 v119, 16, v119
    v_fma_f32 v119, v135, v149, v119
    v_lshlrev_b32 v136, 16, v136
    v_mul_f32 v136, v136, v114
    v_cvt_pk_bf16_f32 v136, v136, v76
    v_and_b32 v148, 0xffff0000, v136
    v_lshlrev_b32 v136, 16, v136
    v_fma_f32 v136, 2.0, v44, v136
    v_mul_f32 v149, 0xbfb8aa3b, v148
    v_exp_f32 v149, v149
    s_nop 0
    v_add_f32 v149, 1.0, v149
    v_rcp_f32 v149, v149
    s_nop 0
    v_mul_f32 v149, v149, v148
    v_cvt_pk_bf16_f32 v149, v149, v149
    v_lshlrev_b32 v149, 16, v149
    v_lshlrev_b32 v120, 16, v120
    v_fma_f32 v120, v136, v149, v120
    v_lshlrev_b32 v137, 16, v137
    v_mul_f32 v137, v137, v114
    v_cvt_pk_bf16_f32 v137, v137, v77
    v_and_b32 v148, 0xffff0000, v137
    v_lshlrev_b32 v137, 16, v137
    v_fma_f32 v137, 2.0, v45, v137
    v_mul_f32 v149, 0xbfb8aa3b, v148
    v_exp_f32 v149, v149
    s_nop 0
    v_add_f32 v149, 1.0, v149
    v_rcp_f32 v149, v149
    s_nop 0
    v_mul_f32 v149, v149, v148
    v_cvt_pk_bf16_f32 v149, v149, v149
    v_lshlrev_b32 v149, 16, v149
    v_lshlrev_b32 v121, 16, v121
    v_fma_f32 v121, v137, v149, v121
    v_lshlrev_b32 v138, 16, v138
    v_mul_f32 v138, v138, v114
    v_cvt_pk_bf16_f32 v138, v138, v78
    v_and_b32 v148, 0xffff0000, v138
    v_lshlrev_b32 v138, 16, v138
    v_fma_f32 v138, 2.0, v46, v138
    v_mul_f32 v149, 0xbfb8aa3b, v148
    v_exp_f32 v149, v149
    s_nop 0
    v_add_f32 v149, 1.0, v149
    v_rcp_f32 v149, v149
    s_nop 0
    v_mul_f32 v149, v149, v148
    v_cvt_pk_bf16_f32 v149, v149, v149
    v_lshlrev_b32 v149, 16, v149
    v_lshlrev_b32 v122, 16, v122
    v_fma_f32 v122, v138, v149, v122
    v_lshlrev_b32 v139, 16, v139
    v_mul_f32 v139, v139, v114
    v_cvt_pk_bf16_f32 v139, v139, v79
    v_and_b32 v148, 0xffff0000, v139
    v_lshlrev_b32 v139, 16, v139
    v_fma_f32 v139, 2.0, v47, v139
    v_mul_f32 v149, 0xbfb8aa3b, v148
    v_exp_f32 v149, v149
    s_nop 0
    v_add_f32 v149, 1.0, v149
    v_rcp_f32 v149, v149
    s_nop 0
    v_mul_f32 v149, v149, v148
    v_cvt_pk_bf16_f32 v149, v149, v149
    v_lshlrev_b32 v149, 16, v149
    v_lshlrev_b32 v123, 16, v123
    v_fma_f32 v123, v139, v149, v123
    v_lshlrev_b32 v140, 16, v140
    v_mul_f32 v140, v140, v114
    v_cvt_pk_bf16_f32 v140, v140, v80
    v_and_b32 v148, 0xffff0000, v140
    v_lshlrev_b32 v140, 16, v140
    v_fma_f32 v140, 2.0, v48, v140
    v_mul_f32 v149, 0xbfb8aa3b, v148
    v_exp_f32 v149, v149
    s_nop 0
    v_add_f32 v149, 1.0, v149
    v_rcp_f32 v149, v149
    s_nop 0
    v_mul_f32 v149, v149, v148
    v_cvt_pk_bf16_f32 v149, v149, v149
    v_lshlrev_b32 v149, 16, v149
    v_lshlrev_b32 v124, 16, v124
    v_fma_f32 v124, v140, v149, v124
    v_lshlrev_b32 v141, 16, v141
    v_mul_f32 v141, v141, v114
    v_cvt_pk_bf16_f32 v141, v141, v81
    v_and_b32 v148, 0xffff0000, v141
    v_lshlrev_b32 v141, 16, v141
    v_fma_f32 v141, 2.0, v49, v141
    v_mul_f32 v149, 0xbfb8aa3b, v148
    v_exp_f32 v149, v149
    s_nop 0
    v_add_f32 v149, 1.0, v149
    v_rcp_f32 v149, v149
    s_nop 0
    v_mul_f32 v149, v149, v148
    v_cvt_pk_bf16_f32 v149, v149, v149
    v_lshlrev_b32 v149, 16, v149
    v_lshlrev_b32 v125, 16, v125
    v_fma_f32 v125, v141, v149, v125
    v_lshlrev_b32 v142, 16, v142
    v_mul_f32 v142, v142, v114
    v_cvt_pk_bf16_f32 v142, v142, v82
    v_and_b32 v148, 0xffff0000, v142
    v_lshlrev_b32 v142, 16, v142
    v_fma_f32 v142, 2.0, v50, v142
    v_mul_f32 v149, 0xbfb8aa3b, v148
    v_exp_f32 v149, v149
    s_nop 0
    v_add_f32 v149, 1.0, v149
    v_rcp_f32 v149, v149
    s_nop 0
    v_mul_f32 v149, v149, v148
    v_cvt_pk_bf16_f32 v149, v149, v149
    v_lshlrev_b32 v149, 16, v149
    v_lshlrev_b32 v126, 16, v126
    v_fma_f32 v126, v142, v149, v126
    v_lshlrev_b32 v143, 16, v143
    v_mul_f32 v143, v143, v114
    v_cvt_pk_bf16_f32 v143, v143, v83
    v_and_b32 v148, 0xffff0000, v143
    v_lshlrev_b32 v143, 16, v143
    v_fma_f32 v143, 2.0, v51, v143
    v_mul_f32 v149, 0xbfb8aa3b, v148
    v_exp_f32 v149, v149
    s_nop 0
    v_add_f32 v149, 1.0, v149
    v_rcp_f32 v149, v149
    s_nop 0
    v_mul_f32 v149, v149, v148
    v_cvt_pk_bf16_f32 v149, v149, v149
    v_lshlrev_b32 v149, 16, v149
    v_lshlrev_b32 v127, 16, v127
    v_fma_f32 v127, v143, v149, v127
    v_lshlrev_b32 v144, 16, v144
    v_mul_f32 v144, v144, v114
    v_cvt_pk_bf16_f32 v144, v144, v84
    v_and_b32 v148, 0xffff0000, v144
    v_lshlrev_b32 v144, 16, v144
    v_fma_f32 v144, 2.0, v52, v144
    v_mul_f32 v149, 0xbfb8aa3b, v148
    v_exp_f32 v149, v149
    s_nop 0
    v_add_f32 v149, 1.0, v149
    v_rcp_f32 v149, v149
    s_nop 0
    v_mul_f32 v149, v149, v148
    v_cvt_pk_bf16_f32 v149, v149, v149
    v_lshlrev_b32 v149, 16, v149
    v_lshlrev_b32 v128, 16, v128
    v_fma_f32 v128, v144, v149, v128
    v_lshlrev_b32 v145, 16, v145
    v_mul_f32 v145, v145, v114
    v_cvt_pk_bf16_f32 v145, v145, v85
    v_and_b32 v148, 0xffff0000, v145
    v_lshlrev_b32 v145, 16, v145
    v_fma_f32 v145, 2.0, v53, v145
    v_mul_f32 v149, 0xbfb8aa3b, v148
    v_exp_f32 v149, v149
    s_nop 0
    v_add_f32 v149, 1.0, v149
    v_rcp_f32 v149, v149
    s_nop 0
    v_mul_f32 v149, v149, v148
    v_cvt_pk_bf16_f32 v149, v149, v149
    v_lshlrev_b32 v149, 16, v149
    v_lshlrev_b32 v129, 16, v129
    v_fma_f32 v129, v145, v149, v129
    v_lshlrev_b32 v146, 16, v146
    v_mul_f32 v146, v146, v114
    v_cvt_pk_bf16_f32 v146, v146, v86
    v_and_b32 v148, 0xffff0000, v146
    v_lshlrev_b32 v146, 16, v146
    v_fma_f32 v146, 2.0, v54, v146
    v_mul_f32 v149, 0xbfb8aa3b, v148
    v_exp_f32 v149, v149
    s_nop 0
    v_add_f32 v149, 1.0, v149
    v_rcp_f32 v149, v149
    s_nop 0
    v_mul_f32 v149, v149, v148
    v_cvt_pk_bf16_f32 v149, v149, v149
    v_lshlrev_b32 v149, 16, v149
    v_lshlrev_b32 v130, 16, v130
    v_fma_f32 v130, v146, v149, v130
    v_lshlrev_b32 v147, 16, v147
    v_mul_f32 v147, v147, v114
    v_cvt_pk_bf16_f32 v147, v147, v87
    v_and_b32 v148, 0xffff0000, v147
    v_lshlrev_b32 v147, 16, v147
    v_fma_f32 v147, 2.0, v55, v147
    v_mul_f32 v149, 0xbfb8aa3b, v148
    v_exp_f32 v149, v149
    s_nop 0
    v_add_f32 v149, 1.0, v149
    v_rcp_f32 v149, v149
    s_nop 0
    v_mul_f32 v149, v149, v148
    v_cvt_pk_bf16_f32 v149, v149, v149
    v_lshlrev_b32 v149, 16, v149
    v_lshlrev_b32 v131, 16, v131
    v_fma_f32 v131, v147, v149, v131
    s_mov_b32 s35, 131072
    buffer_store_dword v116, v150, s[20:23], s35 offen
    s_mov_b32 s35, 135168
    buffer_store_dword v117, v150, s[20:23], s35 offen
    s_mov_b32 s35, 139264
    buffer_store_dword v118, v150, s[20:23], s35 offen
    s_mov_b32 s35, 143360
    buffer_store_dword v119, v150, s[20:23], s35 offen
    s_mov_b32 s35, 163840
    buffer_store_dword v120, v150, s[20:23], s35 offen
    s_mov_b32 s35, 167936
    buffer_store_dword v121, v150, s[20:23], s35 offen
    s_mov_b32 s35, 172032
    buffer_store_dword v122, v150, s[20:23], s35 offen
    s_mov_b32 s35, 176128
    buffer_store_dword v123, v150, s[20:23], s35 offen
    s_mov_b32 s35, 196608
    buffer_store_dword v124, v150, s[20:23], s35 offen
    s_mov_b32 s35, 200704
    buffer_store_dword v125, v150, s[20:23], s35 offen
    s_mov_b32 s35, 204800
    buffer_store_dword v126, v150, s[20:23], s35 offen
    s_mov_b32 s35, 208896
    buffer_store_dword v127, v150, s[20:23], s35 offen
    s_mov_b32 s35, 229376
    buffer_store_dword v128, v150, s[20:23], s35 offen
    s_mov_b32 s35, 233472
    buffer_store_dword v129, v150, s[20:23], s35 offen
    s_mov_b32 s35, 237568
    buffer_store_dword v130, v150, s[20:23], s35 offen
    s_mov_b32 s35, 241664
    buffer_store_dword v131, v150, s[20:23], s35 offen
    s_waitcnt vmcnt(0)
L_fin_done:
    s_endpgm
.section .rodata,"a"
.p2align 6
.amdhsa_kernel ln_kernel
  .amdhsa_next_free_vgpr 40
  .amdhsa_next_free_sgpr 40
  .amdhsa_accum_offset 40
  .amdhsa_group_segment_fixed_size 0
  .amdhsa_kernarg_size 128
  .amdhsa_user_sgpr_count 2
  .amdhsa_user_sgpr_kernarg_segment_ptr 1
  .amdhsa_system_sgpr_workgroup_id_x 1
.end_amdhsa_kernel
.p2align 6
.amdhsa_kernel bu_kernel
  .amdhsa_next_free_vgpr 136
  .amdhsa_next_free_sgpr 96
  .amdhsa_accum_offset 136
  .amdhsa_group_segment_fixed_size 0
  .amdhsa_kernarg_size 128
  .amdhsa_user_sgpr_count 2
  .amdhsa_user_sgpr_kernarg_segment_ptr 1
  .amdhsa_system_sgpr_workgroup_id_x 1
.end_amdhsa_kernel
.p2align 6
.amdhsa_kernel scan_kernel
  .amdhsa_next_free_vgpr 216
  .amdhsa_next_free_sgpr 40
  .amdhsa_accum_offset 216
  .amdhsa_group_segment_fixed_size 0
  .amdhsa_kernarg_size 128
  .amdhsa_user_sgpr_count 2
  .amdhsa_user_sgpr_kernarg_segment_ptr 1
  .amdhsa_system_sgpr_workgroup_id_x 1
.end_amdhsa_kernel
.p2align 6
.amdhsa_kernel ffn1_kernel
  .amdhsa_next_free_vgpr 204
  .amdhsa_next_free_sgpr 96
  .amdhsa_accum_offset 204
  .amdhsa_group_segment_fixed_size 0
  .amdhsa_kernarg_size 128
  .amdhsa_user_sgpr_count 2
  .amdhsa_user_sgpr_kernarg_segment_ptr 1
  .amdhsa_system_sgpr_workgroup_id_x 1
.end_amdhsa_kernel
.p2align 6
.amdhsa_kernel fin_kernel
  .amdhsa_next_free_vgpr 156
  .amdhsa_next_free_sgpr 96
  .amdhsa_accum_offset 156
  .amdhsa_group_segment_fixed_size 0
  .amdhsa_kernarg_size 128
  .amdhsa_user_sgpr_count 2
  .amdhsa_user_sgpr_kernarg_segment_ptr 1
  .amdhsa_system_sgpr_workgroup_id_x 1
.end_amdhsa_kernel
```
